```python
import torch

def _softmax(x, axis=-1):
    return torch.softmax(x, dim=axis)
def _gelu(x):
    return torch.nn.functional.gelu(x, approximate="tanh")
def _silu(x):
    return torch.nn.functional.silu(x)
def _sigmoid(x):
    return torch.sigmoid(x)
def _layernorm(x, axis=-1, eps=1e-5):
    m = x.mean(dim=axis, keepdim=True)
    v = x.var(dim=axis, keepdim=True, unbiased=False)
    return (x - m) / torch.sqrt(v + eps)
def _scatter_add(tgt, idx, src, axis=0):
    return tgt.clone().index_add_(axis, idx, src)
def _segment_sum(src, seg, n):
    out = torch.zeros((n,) + src.shape[1:], dtype=src.dtype)
    return out.index_add_(0, seg, src)
def _pad(x, pw):
    flat = tuple(v for pair in reversed(pw) for v in pair)
    return torch.nn.functional.pad(x, flat)

kernel_name = 'recurrent_scan__ssm_conv_s4__moe_arch_mod__prompt'

def setup_inputs():

    _w = (lambda a: (lambda t: t.to(torch.bfloat16) if t.is_floating_point() else t)(torch.as_tensor(a)))
    def _A_setup():
        B, L, D, N = 1, 2048, 512, 128
        A_re = -(lambda _x: torch.exp(torch.as_tensor(_x)))((lambda *s: torch.randn(*s, dtype=torch.bfloat16) * 6.4)(D, N))
        A_im = torch.pi * (lambda *s: torch.randn(*s, dtype=torch.bfloat16) * 0.05)(D, N)
        B_re = (lambda *s: torch.randn(*s, dtype=torch.bfloat16) * 0.2)(D, N)
        B_im = (lambda *s: torch.randn(*s, dtype=torch.bfloat16) * 0.2)(D, N)
        C_re = (lambda *s: torch.randn(*s, dtype=torch.bfloat16) * 0.2)(D, N)
        C_im = (lambda *s: torch.randn(*s, dtype=torch.bfloat16) * 0.2)(D, N)
        log_dt = (lambda *s: torch.randn(*s, dtype=torch.bfloat16) * 0.05)(D) * 0.5 - 4.0
        Dskip = (lambda *s: torch.randn(*s, dtype=torch.bfloat16) * 0.05)(D)
        return {
            "u": _w((lambda *s: torch.randn(*s, dtype=torch.bfloat16) * 0.05)(B, L, D)),
            "A_re": _w(A_re),
            "A_im": _w(A_im),
            "B_re": _w(B_re),
            "B_im": _w(B_im),
            "C_re": _w(C_re),
            "C_im": _w(C_im),
            "log_dt": _w(log_dt),
            "Dskip": _w(Dskip),
        }
    _A_in = _A_setup()

    def _B_setup():
        B, S, D, F, C = 1, 2048, 512, 1376, 2
        return {
            "x": _w((lambda *s: torch.randn(*s, dtype=torch.bfloat16) * 0.05)(B, S, D)),
            "w_r": _w((lambda *s: torch.randn(*s, dtype=torch.bfloat16) * 6.4)(D)),
            "w_gate": _w((lambda *s: torch.randn(*s, dtype=torch.bfloat16) * 0.1)(D, F)),
            "w_up": _w((lambda *s: torch.randn(*s, dtype=torch.bfloat16) * 0.1)(D, F)),
            "w_down": _w((lambda *s: torch.randn(*s, dtype=torch.bfloat16) * 0.1)(F, D)),
        }
    _B_in = _B_setup()

    return {
        "A_u": _A_in["u"],
        "A_A_re": _A_in["A_re"],
        "A_A_im": _A_in["A_im"],
        "A_B_re": _A_in["B_re"],
        "A_B_im": _A_in["B_im"],
        "A_C_re": _A_in["C_re"],
        "A_C_im": _A_in["C_im"],
        "A_log_dt": _A_in["log_dt"],
        "A_Dskip": _A_in["Dskip"],
        "B_x": _B_in["x"],
        "B_w_r": _B_in["w_r"],
        "B_w_gate": _B_in["w_gate"],
        "B_w_up": _B_in["w_up"],
        "B_w_down": _B_in["w_down"],
    }

def reference(A_u, A_A_re, A_A_im, A_B_re, A_B_im, A_C_re, A_C_im, A_log_dt, A_Dskip, B_x, B_w_r, B_w_gate, B_w_up, B_w_down):
    def _A_ref(u, A_re, A_im, B_re, B_im, C_re, C_im, log_dt, Dskip):
        Bsz, L, D = u.shape
        dt = torch.exp(log_dt)[:, None]
        A = A_re + 1j * A_im
        Bc = B_re + 1j * B_im
        Cc = C_re + 1j * C_im
        logdA = dt * A
        dB = dt * Bc
        l = (lambda x, dt: x.to(dt))(torch.arange(L), A_re.dtype)
        P = torch.exp(logdA[:, :, None] * l[None, None, :])
        K = torch.einsum("dn,dnl,dn->dl", Cc, P, dB).real
        L2 = 2 * L
        Kp = _pad(K, ((0, 0), (0, L)))
        up = (lambda x, *d: x.permute(*d))(u, 0, 2, 1)
        up = _pad(up, ((0, 0), (0, 0), (0, L)))
        Kf = (lambda x, axes=(-2,-1): torch.fft.rfft2(x.float(), dim=axes))(Kp[:, None, :], axes=(-2, -1))
        Uf = (lambda x, axes=(-2,-1): torch.fft.rfft2(x.float(), dim=axes))(up[:, :, None, :], axes=(-2, -1))
        Yf = Uf * Kf[None, :, :, :]
        y = (lambda x, s, axes=(-2,-1): torch.fft.irfft2(x, s=s, dim=axes).to(torch.bfloat16))(Yf, (1, L2), axes=(-2, -1))[:, :, 0, :L]
        y = (lambda x, *d: x.permute(*d))(y, 0, 2, 1) + u * Dskip[None, None, :]
        return y

    def _B_ref(x, w_r, w_gate, w_up, w_down):
        B, S, D = x.shape
        C = 2
        r = x @ w_r
        idx = torch.argsort(-r, axis=-1)[:, :C]
        idx_e = (lambda x, n, axis: torch.repeat_interleave(x, n, dim=axis))(idx.reshape(B, C, 1), D, axis=2)
        x_sel = (lambda x, i, axis: torch.take_along_dim(x, i, dim=axis))(x, idx_e, axis=1)
        g = _silu(x_sel @ w_gate)
        u = x_sel @ w_up
        y = (g * u) @ w_down
        r_sel = _sigmoid((lambda x, i, axis: torch.take_along_dim(x, i, dim=axis))(r, idx, axis=1))
        y = y * r_sel.reshape(B, C, 1)
        b_off = (torch.arange(B) * S).reshape(B, 1)
        flat_idx = (idx + b_off).reshape(B * C)
        zero = (x * 0.0).reshape(B * S, D)
        upd = _scatter_add(zero, flat_idx, y.reshape(B * C, D), axis=0)
        return x + upd.reshape(B, S, D)

    x = A_u
    xn = _layernorm(x, axis=-1)
    s = _A_ref(xn, A_A_re, A_A_im, A_B_re, A_B_im, A_C_re, A_C_im, A_log_dt, A_Dskip)
    g = _silu(_B_ref(xn, B_w_r, B_w_gate, B_w_up, B_w_down))
    return x + s * g
```

```asm
; @launch grid=(256,1,1) block=(512,1,1) lds=146688
.amdgcn_target "amdgcn-amd-amdhsa--gfx950"
.text
.globl recurrent_scan__ssm_conv_s4__moe_arch_mod__prompt_kernel
.p2align 12
.type recurrent_scan__ssm_conv_s4__moe_arch_mod__prompt_kernel,@function
recurrent_scan__ssm_conv_s4__moe_arch_mod__prompt_kernel:
  s_cmp_ge_u32 s2, 256
  s_cbranch_scc1 END
  s_load_dwordx16 s[8:23], s[0:1], 0
  s_load_dwordx16 s[24:39], s[0:1], 64
  s_load_dwordx2 s[40:41], s[0:1], 128
  s_getpc_b64 s[46:47]
PC0:
  s_lshr_b32 s43, s2, 3
  s_lshl_b32 s45, s43, 10
  v_and_b32 v1, 0x1e0, v0
  v_lshl_add_u32 v1, v1, 1, s45
  v_min_u32 v1, END-PC0, v1
  global_load_dword v250, v1, s[46:47]
  v_lshrrev_b32 v1, 6, v0
  v_and_b32 v0, 63, v0
  v_readfirstlane_b32 s3, v1
  s_and_b32 s42, s2, 7
  s_and_b32 s44, s43, 15
  s_lshr_b32 s5, s43, 4
  s_lshl_b32 s4, s42, 4
  s_add_u32 s4, s4, s44
  s_and_b32 s7, s3, 3
  s_mov_b32 s56, 0xffff0000
  s_cmp_gt_u32 s3, 3
  s_cbranch_scc1 IOF
  v_mov_b32 v4, 0
  v_lshlrev_b32 v15, 2, v0
  v_add_u32 v9, 79104, v15
  ds_write_b32 v9, v4
  s_lshl2_add_u32 s42, s4, s7
  s_lshl_b32 s43, s42, 8
  v_add_u32 v15, s43, v15
  s_lshl_b32 s43, s42, 1
  s_and_b32 s43, s43, -4
  s_waitcnt lgkmcnt(0)
  s_load_dword s44, s[22:23], s43
  s_load_dword s46, s[24:25], s43
  global_load_dword v200, v15, s[10:11]
  global_load_dword v201, v15, s[12:13]
  global_load_dword v202, v15, s[14:15]
  global_load_dword v203, v15, s[16:17]
  global_load_dword v204, v15, s[18:19]
  global_load_dword v205, v15, s[20:21]
  s_barrier
  s_branch KG0
IOF:
  s_setprio 2
  s_mul_i32 s6, s42, 11
  s_add_u32 s6, s6, s44
  s_cmp_lt_u32 s6, 86
  s_cselect_b32 s100, 88, 0
  s_add_u32 s100, s100, s6
  s_add_u32 s100, s100, 82
  s_mul_i32 s45, s42, 5
  s_add_u32 s45, s45, s44
  s_add_u32 s45, s45, 117
  s_cmp_lt_u32 s44, 11
  s_cselect_b32 s100, s100, s45
  s_cmp_eq_u32 s5, 0
  s_cselect_b32 s100, s2, s100
  s_mul_i32 s98, s100, 3
  s_cmp_eq_u32 s100, 169
  s_addc_u32 s98, s98, 0
  s_cmp_lt_u32 s100, 168
  s_cselect_b32 s99, 3, 4
  s_cmp_lt_u32 s100, 170
  s_cselect_b32 s99, s99, 0
  s_add_u32 s45, s98, s7
  s_and_b32 s47, s45, -16
  s_mul_i32 s47, s47, 3
  s_add_u32 s47, s47, s45
  s_lshl_b32 s47, s47, 10
  v_and_b32 v5, 3, v0
  v_lshrrev_b32 v7, 2, v0
  v_lshlrev_b32 v8, 4, v7
  v_lshl_add_u32 v9, v5, 14, v8
  v_add_u32 v9, s47, v9
  s_mov_b32 s46, 255885312
  v_and_b32 v12, 15, v0
  v_lshrrev_b32 v13, 4, v0
  v_mov_b32 v1, 79104
  v_mov_b32 v2, 1
  s_cmp_ge_u32 s7, s99
  s_waitcnt lgkmcnt(0)
  s_cbranch_scc1 NXL
  global_load_dwordx4 v[64:67], v9, s[8:9] offset:0
  global_load_dwordx4 v[68:71], v9, s[8:9] offset:256
  global_load_dwordx4 v[72:75], v9, s[8:9] offset:512
  global_load_dwordx4 v[76:79], v9, s[8:9] offset:768
NXL:
  s_load_dword s101, s[40:41], s46
  s_barrier
  s_cbranch_scc1 NWL
  global_load_dwordx4 v[80:83], v8, s[28:29] offset:0
  global_load_dwordx4 v[84:87], v8, s[28:29] offset:256
  global_load_dwordx4 v[88:91], v8, s[28:29] offset:512
  global_load_dwordx4 v[92:95], v8, s[28:29] offset:768
NWL:
  s_add_u32 s40, s40, 251658240
  s_addc_u32 s41, s41, 0
ADDR:
  s_cmp_lt_u32 s44, 11
  s_cselect_b32 s6, s6, 999
  s_cmp_eq_u32 s5, 0
  s_cselect_b32 s6, 999, s6
  s_lshl2_add_u32 s53, s5, s7
  s_lshl2_add_u32 s44, s53, 0x30000
  s_bfe_u32 s51, 0x54327610, s44
  s_bfe_u32 s52, 0x1505432, s44
  v_and_b32 v60, 12, v0
  v_add_u32 v60, v60, v13
  v_lshlrev_b32 v60, 9, v60
  v_lshl_add_u32 v60, v5, 4, v60
  s_and_b32 s47, s4, -4
  s_lshl_b32 s47, s47, 9
  s_and_b32 s44, s4, 2
  s_add_u32 s47, s47, s44
  s_and_b32 s44, s4, 1
  s_lshl2_add_u32 s47, s47, s44
  s_lshl_b32 s47, s47, 3
  v_lshlrev_b32 v4, 4, v12
  v_lshl_add_u32 v4, v13, 9, v4
  s_lshl_b32 s44, s51, 11
  s_add_u32 s44, s44, 4784128
  v_add_u32 v44, s44, v4
  s_lshl_b32 s44, s52, 11
  s_add_u32 s44, s44, 4784128
  v_add_u32 v41, s44, v4
  v_lshlrev_b32 v36, 2, v5
  v_add_u32 v37, 2, v36
  s_lshl_b32 s44, s51, 13
  s_add_u32 s44, s44, s47
  v_add_u32 v45, s44, v60
  s_lshl_b32 s44, s52, 13
  s_add_u32 s44, s44, s47
  v_add_u32 v46, s44, v60
  v_mov_b32 v10, 1
  v_lshl_add_u32 v4, v12, 2, v13
  s_lshl_b32 s44, s51, 18
  s_lshl3_add_u32 s44, s4, s44
  v_lshl_add_u32 v40, v12, 14, s44
  v_mul_u32_u24 v60, 0x1400, v13
  v_and_b32 v60, 0x1800, v60
  v_add_u32 v40, v60, v40
  s_lshl_b32 s44, s51, 9
  s_add_u32 s44, s44, 48896
  v_lshl_add_u32 v47, v4, 3, s44
  s_lshl_b32 s44, s52, 9
  s_add_u32 s44, s44, 48896
  v_lshl_add_u32 v48, v4, 3, s44
  s_lshl_b32 s44, s7, 10
  v_lshl_add_u32 v42, v0, 4, s44
  v_lshl_add_u32 v43, s7, 2, v1
  v_and_b32 v60, 1, v0
  v_lshl_add_u32 v23, v60, 4, v1
  v_lshlrev_b32 v60, 4, v0
  v_add_u32 v52, 4718592, v60
  s_mov_b32 s54, 0x05040100
  s_mov_b32 s55, 0x07060302
  s_lshl2_add_u32 s96, s43, s7
  s_mul_i32 s59, s96, 11008
  s_mul_i32 s97, s42, 352
  s_add_u32 s59, s59, s97
  v_mul_u32_u24 v61, 2752, v13
  v_lshlrev_b32 v62, 6, v12
  v_min_u32 v62, 348, v62
  v_add3_u32 v61, v61, v62, s59
  v_min_u32 v61, 1409020, v61
  global_load_dword v53, v61, s[30:31]
  global_load_dword v54, v61, s[32:33]
  s_mul_i32 s59, s96, 1408
  s_mul_i32 s97, s42, 180224
  s_add_u32 s59, s59, s97
  v_min_u32 v62, 21, v0
  v_lshl_add_u32 v62, v62, 6, s59
  v_min_u32 v62, 1409020, v62
  global_load_dword v55, v62, s[34:35]
  s_cmp_ge_u32 s7, s99
  s_cbranch_scc1 NPF
  s_lshl_b32 s50, s45, 7
  v_lshrrev_b32 v15, 3, v0
  v_lshl_add_u32 v15, v15, 16, s50
  v_and_b32 v60, 7, v0
  v_lshl_add_u32 v15, v60, 4, v15
  s_lshr_b32 s46, s45, 6
  s_lshl_b32 s46, s46, 4
  s_and_b32 s50, s45, 14
  s_add_u32 s46, s46, s50
  s_lshl_b32 s46, s46, 5
  s_and_b32 s50, s45, 48
  s_add_u32 s46, s46, s50
  s_and_b32 s50, s45, 1
  s_lshl1_add_u32 s46, s50, s46
  s_lshl2_add_u32 s46, s46, 4784128
  v_lshl_add_u32 v14, v5, 4, s46
  v_lshlrev_b32 v16, 2, v5
  v_add_u32 v17, 2, v16
  v_mov_b32 v11, 35790849
  s_mov_b32 s51, 0x9fff9fff
  v_bfe_u32 v60, v0, 2, 2
  v_add_u32 v60, s98, v60
  v_and_b32 v6, -16, v60
  v_mad_u32_u24 v6, v6, 3, v60
  v_lshl_add_u32 v6, v5, 4, v6
  v_or_b32 v6, 0x8000, v6
  s_lshl_b32 s46, s7, 6
  s_add_u32 s46, s46, 79360
  v_lshl_add_u32 v8, v5, 4, s46
  v_lshl_add_u32 v8, v13, 2, v8
  v_lshlrev_b32 v9, 4, v12
  v_add_u32 v9, 79360, v9
  s_lshl_b32 s46, s99, 2
  v_cmp_gt_u32 s[62:63], s46, v12
  s_lshl4_add_u32 s50, s100, 4718592
  v_mov_b32 v63, s50
  s_add_u32 s60, s40, 0x80000
  s_addc_u32 s61, s41, 0
  s_add_u32 s46, s40, 0x100000
  s_addc_u32 s47, s41, 0
  s_add_u32 s48, s40, 0x180000
  s_addc_u32 s49, s41, 0
  s_mov_b32 s57, 0x3b003b00
  s_mov_b32 s58, 0x3b000000
  s_sub_u32 s50, s99, 1
  s_waitcnt vmcnt(10)
  v_dot2_f32_bf16 v56, v64, s57, 0
  v_dot2_f32_bf16 v57, v64, v64, 0
  v_dot2_f32_bf16 v58, v65, s57, 0
  v_dot2_f32_bf16 v59, v65, v65, 0
  v_dot2_f32_bf16 v56, v66, s57, v56
  v_dot2_f32_bf16 v57, v66, v66, v57
  v_dot2_f32_bf16 v58, v67, s57, v58
  v_dot2_f32_bf16 v59, v67, v67, v59
  s_waitcnt vmcnt(9)
  v_dot2_f32_bf16 v56, v68, s57, v56
  v_dot2_f32_bf16 v57, v68, v68, v57
  v_dot2_f32_bf16 v58, v69, s57, v58
  v_dot2_f32_bf16 v59, v69, v69, v59
  v_dot2_f32_bf16 v56, v70, s57, v56
  v_dot2_f32_bf16 v57, v70, v70, v57
  v_dot2_f32_bf16 v58, v71, s57, v58
  v_dot2_f32_bf16 v59, v71, v71, v59
  s_waitcnt vmcnt(8)
  v_dot2_f32_bf16 v56, v72, s57, v56
  v_dot2_f32_bf16 v57, v72, v72, v57
  v_dot2_f32_bf16 v58, v73, s57, v58
  v_dot2_f32_bf16 v59, v73, v73, v59
  v_dot2_f32_bf16 v56, v74, s57, v56
  v_dot2_f32_bf16 v57, v74, v74, v57
  v_dot2_f32_bf16 v58, v75, s57, v58
  v_dot2_f32_bf16 v59, v75, v75, v59
  s_waitcnt vmcnt(7)
  v_dot2_f32_bf16 v56, v76, s57, v56
  v_dot2_f32_bf16 v57, v76, v76, v57
  v_dot2_f32_bf16 v58, v77, s57, v58
  v_dot2_f32_bf16 v59, v77, v77, v59
  v_dot2_f32_bf16 v56, v78, s57, v56
  v_dot2_f32_bf16 v57, v78, v78, v57
  v_dot2_f32_bf16 v58, v79, s57, v58
  v_dot2_f32_bf16 v59, v79, v79, v59
  v_lshlrev_b32 v96, 16, v64
  v_and_b32 v97, s56, v64
  v_lshlrev_b32 v98, 16, v65
  v_pk_add_f32 v[56:57], v[56:57], v[58:59]
  v_and_b32 v99, s56, v65
  v_lshlrev_b32 v100, 16, v66
  v_permlane32_swap_b32 v56, v57
  v_add_f32 v58, v56, v57
  v_add_f32 v59, v56, v57
  v_and_b32 v101, s56, v66
  v_lshlrev_b32 v102, 16, v67
  v_permlane16_swap_b32 v58, v59
  v_add_f32 v58, v58, v59
  v_and_b32 v103, s56, v67
  v_lshlrev_b32 v104, 16, v68
  v_add_f32_dpp v58, v58, v58 row_ror:4 row_mask:0xf bank_mask:0xf
  v_and_b32 v105, s56, v68
  v_lshlrev_b32 v106, 16, v69
  v_add_f32_dpp v56, v58, v58 row_ror:8 row_mask:0xf bank_mask:0xf
  v_add_f32_dpp v57, v58, v58 row_ror:8 row_mask:0xf bank_mask:0xf
  s_waitcnt lgkmcnt(0)
  v_add_u32 v11, s101, v11
  v_and_b32 v107, s56, v69
  v_permlane32_swap_b32 v56, v57
  v_mul_f32 v58, v56, v56
  v_fma_f32 v57, v57, s58, -v58
  v_max_f32 v57, 0, v57
  v_cvt_pk_bf16_f32 v57, v57, v57
  v_and_b32 v57, s56, v57
  v_add_f32 v57, 0x3727c5ac, v57
  v_cvt_pk_bf16_f32 v57, v57, v57
  v_and_b32 v57, s56, v57
  v_sqrt_f32 v57, v57
  v_alignbit_b32 v16, v11, v11, v16
  v_alignbit_b32 v17, v11, v11, v17
  v_cvt_pk_bf16_f32 v10, v56, v57
  v_and_b32 v58, s56, v10
  v_rcp_f32 v58, v58
  v_lshlrev_b32 v60, 16, v10
  v_and_b32 v16, 1610637312, v16
  v_mul_f32 v58, 0x97b8aa3b, v58
  v_mul_f32_e64 v60, -v60, v58
  s_mov_b64 exec, 15
  global_store_dwordx2 v14, v[10:11], s[40:41] sc1
  s_mov_b64 exec, -1
  v_and_b32 v17, 1610637312, v17
  v_pk_fma_f32 v[96:97], v[96:97], v[58:59], v[60:61] op_sel_hi:[1,0,0]
  v_pk_fma_f32 v[98:99], v[98:99], v[58:59], v[60:61] op_sel_hi:[1,0,0]
  v_pk_fma_f32 v[100:101], v[100:101], v[58:59], v[60:61] op_sel_hi:[1,0,0]
  v_pk_fma_f32 v[102:103], v[102:103], v[58:59], v[60:61] op_sel_hi:[1,0,0]
  v_cvt_pk_bf16_f32 v144, v96, v97
  v_cvt_pk_bf16_f32 v145, v98, v99
  v_cvt_pk_bf16_f32 v146, v100, v101
  v_cvt_pk_bf16_f32 v147, v102, v103
  v_and_or_b32 v128, v144, s51, v16
  v_and_or_b32 v129, v145, s51, v17
  v_and_or_b32 v130, v146, s51, v16
  v_and_or_b32 v131, v147, s51, v17
  global_store_dwordx4 v15, v[128:131], s[40:41] sc1
  v_lshlrev_b32 v108, 16, v70
  v_and_b32 v109, s56, v70
  v_lshlrev_b32 v110, 16, v71
  v_and_b32 v111, s56, v71
  v_pk_fma_f32 v[104:105], v[104:105], v[58:59], v[60:61] op_sel_hi:[1,0,0]
  v_pk_fma_f32 v[106:107], v[106:107], v[58:59], v[60:61] op_sel_hi:[1,0,0]
  v_pk_fma_f32 v[108:109], v[108:109], v[58:59], v[60:61] op_sel_hi:[1,0,0]
  v_pk_fma_f32 v[110:111], v[110:111], v[58:59], v[60:61] op_sel_hi:[1,0,0]
  v_cvt_pk_bf16_f32 v148, v104, v105
  v_cvt_pk_bf16_f32 v149, v106, v107
  v_cvt_pk_bf16_f32 v150, v108, v109
  v_cvt_pk_bf16_f32 v151, v110, v111
  v_and_or_b32 v132, v148, s51, v16
  v_and_or_b32 v133, v149, s51, v17
  v_and_or_b32 v134, v150, s51, v16
  v_and_or_b32 v135, v151, s51, v17
  global_store_dwordx4 v15, v[132:135], s[60:61] sc1
  v_lshlrev_b32 v112, 16, v72
  v_and_b32 v113, s56, v72
  v_lshlrev_b32 v114, 16, v73
  v_and_b32 v115, s56, v73
  v_lshlrev_b32 v116, 16, v74
  v_and_b32 v117, s56, v74
  v_lshlrev_b32 v118, 16, v75
  v_and_b32 v119, s56, v75
  v_pk_fma_f32 v[112:113], v[112:113], v[58:59], v[60:61] op_sel_hi:[1,0,0]
  v_pk_fma_f32 v[114:115], v[114:115], v[58:59], v[60:61] op_sel_hi:[1,0,0]
  v_pk_fma_f32 v[116:117], v[116:117], v[58:59], v[60:61] op_sel_hi:[1,0,0]
  v_pk_fma_f32 v[118:119], v[118:119], v[58:59], v[60:61] op_sel_hi:[1,0,0]
  v_cvt_pk_bf16_f32 v152, v112, v113
  v_cvt_pk_bf16_f32 v153, v114, v115
  v_cvt_pk_bf16_f32 v154, v116, v117
  v_cvt_pk_bf16_f32 v155, v118, v119
  v_and_or_b32 v136, v152, s51, v16
  v_and_or_b32 v137, v153, s51, v17
  v_and_or_b32 v138, v154, s51, v16
  v_and_or_b32 v139, v155, s51, v17
  global_store_dwordx4 v15, v[136:139], s[46:47] sc1
  v_lshlrev_b32 v120, 16, v76
  v_and_b32 v121, s56, v76
  v_lshlrev_b32 v122, 16, v77
  v_and_b32 v123, s56, v77
  v_lshlrev_b32 v124, 16, v78
  v_and_b32 v125, s56, v78
  v_lshlrev_b32 v126, 16, v79
  v_and_b32 v127, s56, v79
  v_pk_fma_f32 v[120:121], v[120:121], v[58:59], v[60:61] op_sel_hi:[1,0,0]
  v_pk_fma_f32 v[122:123], v[122:123], v[58:59], v[60:61] op_sel_hi:[1,0,0]
  v_pk_fma_f32 v[124:125], v[124:125], v[58:59], v[60:61] op_sel_hi:[1,0,0]
  v_pk_fma_f32 v[126:127], v[126:127], v[58:59], v[60:61] op_sel_hi:[1,0,0]
  v_cvt_pk_bf16_f32 v156, v120, v121
  v_cvt_pk_bf16_f32 v157, v122, v123
  v_cvt_pk_bf16_f32 v158, v124, v125
  v_cvt_pk_bf16_f32 v159, v126, v127
  v_and_or_b32 v140, v156, s51, v16
  v_and_or_b32 v141, v157, s51, v17
  v_and_or_b32 v142, v158, s51, v16
  v_and_or_b32 v143, v159, s51, v17
  global_store_dwordx4 v15, v[140:143], s[48:49] sc1
  s_waitcnt vmcnt(8)
  v_dot2_f32_bf16 v56, v144, v80, 0
  v_dot2_f32_bf16 v57, v145, v81, 0
  v_dot2_f32_bf16 v58, v146, v82, 0
  v_dot2_f32_bf16 v59, v147, v83, 0
  v_dot2_f32_bf16 v56, v148, v84, v56
  v_dot2_f32_bf16 v57, v149, v85, v57
  v_dot2_f32_bf16 v58, v150, v86, v58
  v_dot2_f32_bf16 v59, v151, v87, v59
  v_dot2_f32_bf16 v56, v152, v88, v56
  v_dot2_f32_bf16 v57, v153, v89, v57
  v_dot2_f32_bf16 v58, v154, v90, v58
  v_dot2_f32_bf16 v59, v155, v91, v59
  v_dot2_f32_bf16 v56, v156, v92, v56
  v_dot2_f32_bf16 v57, v157, v93, v57
  v_dot2_f32_bf16 v58, v158, v94, v58
  v_dot2_f32_bf16 v59, v159, v95, v59
  s_nop 2
  v_pk_add_f32 v[56:57], v[56:57], v[58:59]
  v_add_f32 v56, v56, v57
  s_nop 1
  v_add_f32_dpp v56, v56, v56 row_ror:4 row_mask:0xf bank_mask:0xf
  s_nop 1
  v_add_f32_dpp v56, v56, v56 row_ror:8 row_mask:0xf bank_mask:0xf
  v_mov_b32 v62, v11
  ds_write_b32 v8, v56
  s_mov_b64 exec, 1
  ds_add_rtn_u32 v3, v1, v2 offset:20
  s_mov_b64 exec, -1
  ds_read_b128 v[56:59], v9
  s_waitcnt lgkmcnt(0)
  v_readfirstlane_b32 s58, v3
  v_add_f32 v56, v56, v57
  v_add_f32 v58, v58, v59
  s_cmp_lg_u32 s58, s50
  s_cbranch_scc1 NOKEYST
  v_add_f32 v56, v56, v58
  v_mul_f32 v56, 0xe7317218, v56
  v_cvt_pk_bf16_f32 v56, v56, v56
  v_ashrrev_i32 v57, 31, v56
  v_or_b32 v57, 0x80000000, v57
  v_xor_b32 v56, v56, v57
  v_and_or_b32 v56, v56, s56, v6
  v_cndmask_b32 v56, 0, v56, s[62:63]
  s_nop 1
  v_max_u32_dpp v60, v56, v56 quad_perm:[1,0,3,2] row_mask:0xf bank_mask:0xf
  v_min_u32_dpp v61, v56, v56 quad_perm:[1,0,3,2] row_mask:0xf bank_mask:0xf
  s_nop 0
  v_min_u32_dpp v57, v60, v60 quad_perm:[2,3,0,1] row_mask:0xf bank_mask:0xf
  v_max_u32_dpp v60, v60, v60 quad_perm:[2,3,0,1] row_mask:0xf bank_mask:0xf
  v_max_u32_dpp v61, v61, v61 quad_perm:[2,3,0,1] row_mask:0xf bank_mask:0xf
  v_max_u32 v61, v61, v57
  v_min_u32_dpp v57, v60, v60 row_half_mirror row_mask:0xf bank_mask:0xf
  v_max_u32_dpp v60, v60, v60 row_half_mirror row_mask:0xf bank_mask:0xf
  v_max_u32_dpp v61, v61, v61 row_half_mirror row_mask:0xf bank_mask:0xf
  v_max_u32 v61, v61, v57
  v_min_u32_dpp v57, v60, v60 row_mirror row_mask:0xf bank_mask:0xf
  v_max_u32_dpp v60, v60, v60 row_mirror row_mask:0xf bank_mask:0xf
  v_max_u32_dpp v61, v61, v61 row_mirror row_mask:0xf bank_mask:0xf
  v_max_u32 v61, v61, v57
  s_mov_b64 exec, 1
  global_store_dwordx3 v63, v[60:62], s[40:41] sc1
  s_mov_b64 exec, -1
NOKEYST:
  v_mov_b32 v10, 1
NPF:
  s_cmp_gt_u32 s6, 85
  s_cselect_b32 s44, 3, 0
  s_branch TIO
RIO:
  s_cmp_eq_u32 s53, 7
  s_cbranch_scc1 SERV
  s_cmp_ge_u32 s7, s99
  s_cbranch_scc1 T1W
  s_waitcnt vmcnt(0)
  ds_write_b64 v1, v[10:11] offset:64
SWP:
  s_mov_b32 s59, 0
  v_mov_b32 v22, 0
SWL:
  s_cmp_lg_u32 s53, 5
  s_cbranch_scc1 SW1
  global_load_dwordx4 v[88:91], v41, s[40:41] offset:0 sc1
  global_load_dwordx4 v[92:95], v41, s[40:41] offset:256 sc1
SW1:
  global_load_dwordx4 v[72:75], v44, s[40:41] offset:0 sc1
  global_load_dwordx4 v[76:79], v44, s[40:41] offset:256 sc1
  global_load_dwordx2 v[80:81], v46, s[40:41] offset:0 sc1
  global_load_dwordx2 v[82:83], v46, s[40:41] offset:128 sc1
  global_load_dwordx2 v[84:85], v46, s[40:41] offset:256 sc1
  global_load_dwordx2 v[86:87], v46, s[40:41] offset:384 sc1
  global_load_dwordx2 v[64:65], v45, s[40:41] offset:0 sc1
  global_load_dwordx2 v[66:67], v45, s[40:41] offset:128 sc1
  global_load_dwordx2 v[68:69], v45, s[40:41] offset:256 sc1
  global_load_dwordx2 v[70:71], v45, s[40:41] offset:384 sc1
  v_alignbit_b32 v16, v11, v11, v36
  v_alignbit_b32 v17, v11, v11, v37
  v_and_b32 v16, 1610637312, v16
  v_and_b32 v17, 1610637312, v17
  v_sub_u32 v38, 671098880, v16
  v_sub_u32 v39, 671098880, v17
  s_mov_b32 s58, 1610637312
  s_waitcnt vmcnt(8)
  s_cbranch_scc1 SW2
  v_bitop3_b32 v22, v89, v91, v11 bitop3:0x7e
  v_bitop3_b32 v21, v93, v95, v11 bitop3:0x7e
  v_or_b32 v22, v22, v21
SW2:
  v_bitop3_b32 v20, v73, v75, v11 bitop3:0x7e
  v_bitop3_b32 v21, v77, v79, v11 bitop3:0x7e
  v_or3_b32 v21, v20, v21, v22
  s_add_u32 s59, s59, 1
  s_waitcnt vmcnt(4)
  v_bitop3_b32 v24, v80, v82, v16 bitop3:0x7e
  v_bitop3_b32 v25, v81, v83, v17 bitop3:0x7e
  v_bitop3_b32 v26, v84, v86, v16 bitop3:0x7e
  v_bitop3_b32 v27, v85, v87, v17 bitop3:0x7e
  v_add_u32 v80, v80, v38
  v_add_u32 v81, v81, v39
  v_add_u32 v82, v82, v38
  v_add_u32 v83, v83, v39
  v_add_u32 v84, v84, v38
  v_add_u32 v85, v85, v39
  v_add_u32 v86, v86, v38
  v_add_u32 v87, v87, v39
  v_perm_b32 v96, v82, v80, s54
  v_perm_b32 v97, v86, v84, s54
  v_perm_b32 v98, v82, v80, s55
  v_perm_b32 v99, v86, v84, s55
  v_perm_b32 v100, v83, v81, s54
  v_perm_b32 v101, v87, v85, s54
  v_perm_b32 v102, v83, v81, s55
  v_perm_b32 v103, v87, v85, s55
  ds_write_b64 v48, v[96:97] offset:0
  ds_write_b64 v48, v[98:99] offset:4608
  ds_write_b64 v48, v[100:101] offset:9216
  ds_write_b64 v48, v[102:103] offset:13824
  v_or3_b32 v20, v24, v25, v26
  v_or_b32 v20, v20, v27
  s_waitcnt vmcnt(0)
  v_bitop3_b32 v24, v64, v66, v16 bitop3:0x7e
  v_bitop3_b32 v25, v65, v67, v17 bitop3:0x7e
  v_bitop3_b32 v26, v68, v70, v16 bitop3:0x7e
  v_bitop3_b32 v27, v69, v71, v17 bitop3:0x7e
  v_add_u32 v64, v64, v38
  v_add_u32 v65, v65, v39
  v_add_u32 v66, v66, v38
  v_add_u32 v67, v67, v39
  v_add_u32 v68, v68, v38
  v_add_u32 v69, v69, v39
  v_add_u32 v70, v70, v38
  v_add_u32 v71, v71, v39
  v_perm_b32 v104, v66, v64, s54
  v_perm_b32 v105, v70, v68, s54
  v_perm_b32 v106, v66, v64, s55
  v_perm_b32 v107, v70, v68, s55
  v_perm_b32 v108, v67, v65, s54
  v_perm_b32 v109, v71, v69, s54
  v_perm_b32 v110, v67, v65, s55
  v_perm_b32 v111, v71, v69, s55
  ds_write_b64 v47, v[104:105] offset:0
  ds_write_b64 v47, v[106:107] offset:4608
  ds_write_b64 v47, v[108:109] offset:9216
  ds_write_b64 v47, v[110:111] offset:13824
  v_or3_b32 v20, v20, v24, v25
  v_or3_b32 v20, v20, v26, v27
  v_and_or_b32 v20, v20, s58, v21
  s_cmp_gt_u32 s59, 20000
  v_cmp_ne_u32 vcc, 0, v20
  s_cbranch_scc1 SWD
  s_wqm_b64 exec, vcc
  s_cbranch_execnz SWL
SWD:
  s_mov_b64 exec, 1
  ds_add_u32 v1, v2 offset:0
  s_mov_b64 exec, -1
  s_setprio 0
  s_cmp_lg_u32 s7, 3
  s_cbranch_scc1 AFTK
  global_load_dwordx3 v[24:26], v52, s[40:41] offset:0 sc1
  global_load_dwordx3 v[28:30], v52, s[40:41] offset:1024 sc1
  global_load_dwordx3 v[32:34], v52, s[40:41] offset:2048 sc1
  s_branch AFTK
T1W:
  s_setprio 0
  s_mov_b32 s59, 0
SPIN_1:
  ds_read_b32 v3, v1 offset:64
  ds_read_b32 v11, v1 offset:68
  s_add_u32 s59, s59, 1
  s_cmp_gt_u32 s59, 320000
  s_cbranch_scc1 SPD_2
  s_waitcnt lgkmcnt(0)
  v_readfirstlane_b32 s58, v3
  s_cmp_eq_u32 s58, 0
  s_cbranch_scc1 SPIN_1
SPD_2:
  s_waitcnt lgkmcnt(0)
  s_setprio 2
  s_branch SWP
.p2align 12
TIO:
  s_cmp_lg_u32 s7, s44
  s_cbranch_scc1 RIO
  s_setprio 2
  s_cmp_eq_u32 s5, 1
  s_cbranch_scc1 TC1
  s_branch TC0
RTC:
  v_mov_b64 v[172:173], 0
  v_mov_b64 v[174:175], 0
  s_mov_b32 s48, 66880
  v_lshl_add_u32 v196, v12, 6, s48
  v_lshl_add_u32 v161, v13, 4, v196
  v_lshl_add_u32 v160, v13, 5, v196
  v_add_u32 v160, 1008, v160
  s_mov_b32 s49, 68912
  v_writelane_b32 v160, s49, 32
  s_mov_b32 s49, 69184
  v_lshl_add_u32 v162, v0, 3, s49
  v_add_u32 v163, 4, v162
  s_mov_b32 s49, 69376
  v_lshl_add_u32 v196, v13, 5, v12
  s_mov_b32 exec_lo, 0
  v_lshl_add_u32 v162, v196, 2, s49
  v_add_u32 v163, 64, v162
  s_mov_b32 exec_lo, -1
  v_lshlrev_b32 v196, 2, v13
  v_sub_u32 v196, v12, v196
  v_lshl_add_u32 v168, v196, 2, s49
  s_mov_b32 s49, 68928
  v_lshl_add_u32 v167, v196, 3, s49
  v_lshlrev_b32 v197, 3, v13
  v_sub_u32 v196, v12, v197
  s_add_u32 s49, s48, 40
  v_lshl_add_u32 v164, v196, 2, s49
  v_add_u32 v165, 1024, v164
  v_add_u32 v166, 2048, v164
  s_mov_b32 s49, 48384
  v_lshl_add_u32 v196, v13, 4, s49
  v_lshl_add_u32 v169, v12, 5, v196
  v_lshlrev_b32 v170, 4, v0
  v_mov_b32 v171, v1
  v_lshl_add_u32 v196, v0, 3, s49
  ds_write_b64 v196, v[172:173] offset:0
  ds_write_b64 v196, v[172:173] offset:4608
  ds_write_b64 v196, v[172:173] offset:9216
  ds_write_b64 v196, v[172:173] offset:13824
  v_add_u32 v198, 66816, v170
  v_and_b32 v170, 0x1f0, v170
  v_lshrrev_b32 v196, 5, v0
  v_lshl_add_u32 v170, v196, 3, v170
  s_movk_i32 s48, 3072
  s_mov_b32 s49, 0
HLL:
  ds_write_b128 v198, v[160:163] offset:12800
  ds_write_b128 v198, v[172:175] offset:0
  ds_write_b128 v198, v[164:167] offset:13824
  ds_write_b128 v198, v[172:175] offset:1024
  ds_write_b128 v198, v[168:171] offset:14848
  ds_write_b128 v198, v[172:175] offset:2048
  s_add_u32 s49, s49, 1
  s_cmp_lt_u32 s49, 4
  v_add_u32 v198, s48, v198
  v_add_u32 v160, s48, v160
  v_add_u32 v161, s48, v161
  v_add_u32 v162, s48, v162
  v_add_u32 v163, s48, v163
  v_add_u32 v164, s48, v164
  v_add_u32 v165, s48, v165
  v_add_u32 v166, s48, v166
  v_add_u32 v167, s48, v167
  v_add_u32 v168, s48, v168
  v_add_u32 v169, 4608, v169
  v_add_u32 v170, 12096, v170
  v_add_u32 v171, 1, v171
  s_cbranch_scc1 HLL
  v_lshlrev_b32 v160, v12, v2
  v_mul_u32_u24 v196, 14336, v160
  v_bfe_u32 v196, v196, v197, 8
  v_lshl_or_b32 v196, v196, 15, v196
  v_and_b32 v161, 65537, v196
  v_mul_u32_u24 v176, 16256, v161
  v_and_b32 v161, 262148, v196
  v_mul_u32_u24 v177, 4064, v161
  v_and_b32 v161, 1048592, v196
  v_mul_u32_u24 v178, 1016, v161
  v_and_b32 v161, 4194368, v196
  v_mul_u32_u24 v179, 254, v161
  ds_write_b128 v198, v[176:179] offset:12800
  v_mul_u32_u24 v196, 1984, v160
  v_bfe_u32 v196, v196, v197, 8
  v_lshl_or_b32 v196, v196, 15, v196
  v_and_b32 v161, 65537, v196
  v_mul_u32_u24 v180, 16256, v161
  v_and_b32 v161, 262148, v196
  v_mul_u32_u24 v181, 4064, v161
  v_and_b32 v161, 1048592, v196
  v_mul_u32_u24 v182, 1016, v161
  v_and_b32 v161, 4194368, v196
  v_mul_u32_u24 v183, 254, v161
  ds_write_b128 v198, v[180:183] offset:13824
  v_mul_u32_u24 v196, 4064, v160
  v_bfe_u32 v196, v196, v197, 8
  v_lshl_or_b32 v196, v196, 15, v196
  v_and_b32 v161, 65537, v196
  v_mul_u32_u24 v184, 16256, v161
  v_and_b32 v161, 262148, v196
  v_mul_u32_u24 v185, 4064, v161
  v_and_b32 v161, 1048592, v196
  v_mul_u32_u24 v186, 1016, v161
  v_and_b32 v161, 4194368, v196
  v_mul_u32_u24 v187, 254, v161
  ds_write_b128 v198, v[184:187] offset:14848
  v_mul_u32_u24 v196, 8176, v160
  v_bfe_u32 v196, v196, v197, 8
  v_lshl_or_b32 v196, v196, 15, v196
  v_and_b32 v161, 65537, v196
  v_mul_u32_u24 v188, 16256, v161
  v_and_b32 v161, 262148, v196
  v_mul_u32_u24 v189, 4064, v161
  v_and_b32 v161, 1048592, v196
  v_mul_u32_u24 v190, 1016, v161
  v_and_b32 v161, 4194368, v196
  v_mul_u32_u24 v191, 254, v161
  ds_write_b128 v198, v[188:191] offset:15872
  v_mul_u32_u24 v196, 12288, v160
  v_bfe_u32 v196, v196, v197, 8
  v_lshl_or_b32 v196, v196, 15, v196
  v_lshrrev_b32 v161, 0, v196
  v_and_b32 v192, 0x10001, v161
  v_lshrrev_b32 v161, 2, v196
  v_and_b32 v193, 0x10001, v161
  v_lshrrev_b32 v161, 4, v196
  v_and_b32 v194, 0x10001, v161
  v_lshrrev_b32 v161, 6, v196
  v_and_b32 v195, 0x10001, v161
  ds_write_b128 v198, v[192:195] offset:16896
  ds_write_b32 v1, v2 offset:24
  s_branch RIO
AFTK:
  v_permlane32_swap_b32 v64, v68
  v_permlane32_swap_b32 v65, v69
  v_permlane32_swap_b32 v72, v76
  v_permlane32_swap_b32 v66, v70
  v_permlane32_swap_b32 v67, v71
  v_permlane32_swap_b32 v74, v78
  v_lshlrev_b32 v144, 16, v64
  v_and_b32 v145, s56, v64
  v_lshlrev_b32 v146, 16, v65
  v_and_b32 v147, s56, v65
  v_exp_f32 v148, v144
  v_exp_f32 v149, v145
  v_exp_f32 v150, v146
  v_exp_f32 v151, v147
  v_and_b32 v64, s56, v72
  v_lshlrev_b32 v65, 16, v72
  v_mul_f32 v64, 0xbf317218, v64
  v_add_f32 v148, 1.0, v148
  v_add_f32 v149, 1.0, v149
  v_add_f32 v150, 1.0, v150
  v_add_f32 v151, 1.0, v151
  v_rcp_f32 v148, v148
  v_rcp_f32 v149, v149
  v_rcp_f32 v150, v150
  v_rcp_f32 v151, v151
  v_fma_f32 v112, v144, v64, v65
  v_fma_f32 v113, v145, v64, v65
  v_fma_f32 v114, v146, v64, v65
  v_fma_f32 v115, v147, v64, v65
  v_mul_f32 v96, v148, v144
  v_mul_f32 v97, v149, v145
  v_mul_f32 v98, v150, v146
  v_mul_f32 v99, v151, v147
  v_lshlrev_b32 v152, 16, v66
  v_and_b32 v153, s56, v66
  v_lshlrev_b32 v154, 16, v67
  v_and_b32 v155, s56, v67
  v_exp_f32 v156, v152
  v_exp_f32 v157, v153
  v_exp_f32 v158, v154
  v_exp_f32 v159, v155
  v_and_b32 v66, s56, v74
  v_lshlrev_b32 v67, 16, v74
  v_mul_f32 v66, 0xbf317218, v66
  v_add_f32 v156, 1.0, v156
  v_add_f32 v157, 1.0, v157
  v_add_f32 v158, 1.0, v158
  v_add_f32 v159, 1.0, v159
  v_rcp_f32 v156, v156
  v_rcp_f32 v157, v157
  v_rcp_f32 v158, v158
  v_rcp_f32 v159, v159
  v_fma_f32 v116, v152, v66, v67
  v_fma_f32 v117, v153, v66, v67
  v_fma_f32 v118, v154, v66, v67
  v_fma_f32 v119, v155, v66, v67
  v_mul_f32 v100, v156, v152
  v_mul_f32 v101, v157, v153
  v_mul_f32 v102, v158, v154
  v_mul_f32 v103, v159, v155
  v_lshlrev_b32 v144, 16, v68
  v_and_b32 v145, s56, v68
  v_lshlrev_b32 v146, 16, v69
  v_and_b32 v147, s56, v69
  v_exp_f32 v148, v144
  v_exp_f32 v149, v145
  v_exp_f32 v150, v146
  v_exp_f32 v151, v147
  v_and_b32 v68, s56, v76
  v_lshlrev_b32 v69, 16, v76
  v_mul_f32 v68, 0xbf317218, v68
  v_add_f32 v148, 1.0, v148
  v_add_f32 v149, 1.0, v149
  v_add_f32 v150, 1.0, v150
  v_add_f32 v151, 1.0, v151
  v_rcp_f32 v148, v148
  v_rcp_f32 v149, v149
  v_rcp_f32 v150, v150
  v_rcp_f32 v151, v151
  v_fma_f32 v120, v144, v68, v69
  v_fma_f32 v121, v145, v68, v69
  v_fma_f32 v122, v146, v68, v69
  v_fma_f32 v123, v147, v68, v69
  v_mul_f32 v104, v148, v144
  v_mul_f32 v105, v149, v145
  v_mul_f32 v106, v150, v146
  v_mul_f32 v107, v151, v147
  v_lshlrev_b32 v152, 16, v70
  v_and_b32 v153, s56, v70
  v_lshlrev_b32 v154, 16, v71
  v_and_b32 v155, s56, v71
  v_exp_f32 v156, v152
  v_exp_f32 v157, v153
  v_exp_f32 v158, v154
  v_exp_f32 v159, v155
  v_and_b32 v70, s56, v78
  v_lshlrev_b32 v71, 16, v78
  v_mul_f32 v70, 0xbf317218, v70
  v_add_f32 v156, 1.0, v156
  v_add_f32 v157, 1.0, v157
  v_add_f32 v158, 1.0, v158
  v_add_f32 v159, 1.0, v159
  v_rcp_f32 v156, v156
  v_rcp_f32 v157, v157
  v_rcp_f32 v158, v158
  v_rcp_f32 v159, v159
  v_fma_f32 v124, v152, v70, v71
  v_fma_f32 v125, v153, v70, v71
  v_fma_f32 v126, v154, v70, v71
  v_fma_f32 v127, v155, v70, v71
  v_mul_f32 v108, v156, v152
  v_mul_f32 v109, v157, v153
  v_mul_f32 v110, v158, v154
  v_mul_f32 v111, v159, v155
  s_cmp_eq_u32 s7, 3
  s_cbranch_scc1 KP0
  s_cmp_lg_u32 s53, 5
  s_cbranch_scc1 AFTP
  v_permlane32_swap_b32 v80, v84
  v_permlane32_swap_b32 v81, v85
  v_permlane32_swap_b32 v88, v92
  v_permlane32_swap_b32 v82, v86
  v_permlane32_swap_b32 v83, v87
  v_permlane32_swap_b32 v90, v94
  v_lshlrev_b32 v144, 16, v80
  v_and_b32 v145, s56, v80
  v_lshlrev_b32 v146, 16, v81
  v_and_b32 v147, s56, v81
  v_exp_f32 v148, v144
  v_exp_f32 v149, v145
  v_exp_f32 v150, v146
  v_exp_f32 v151, v147
  v_and_b32 v80, s56, v88
  v_lshlrev_b32 v81, 16, v88
  v_mul_f32 v80, 0xbf317218, v80
  v_add_f32 v148, 1.0, v148
  v_add_f32 v149, 1.0, v149
  v_add_f32 v150, 1.0, v150
  v_add_f32 v151, 1.0, v151
  v_rcp_f32 v148, v148
  v_rcp_f32 v149, v149
  v_rcp_f32 v150, v150
  v_rcp_f32 v151, v151
  v_fma_f32 v208, v144, v80, v81
  v_fma_f32 v209, v145, v80, v81
  v_fma_f32 v210, v146, v80, v81
  v_fma_f32 v211, v147, v80, v81
  v_mul_f32 v192, v148, v144
  v_mul_f32 v193, v149, v145
  v_mul_f32 v194, v150, v146
  v_mul_f32 v195, v151, v147
  v_lshlrev_b32 v152, 16, v82
  v_and_b32 v153, s56, v82
  v_lshlrev_b32 v154, 16, v83
  v_and_b32 v155, s56, v83
  v_exp_f32 v156, v152
  v_exp_f32 v157, v153
  v_exp_f32 v158, v154
  v_exp_f32 v159, v155
  v_and_b32 v82, s56, v90
  v_lshlrev_b32 v83, 16, v90
  v_mul_f32 v82, 0xbf317218, v82
  v_add_f32 v156, 1.0, v156
  v_add_f32 v157, 1.0, v157
  v_add_f32 v158, 1.0, v158
  v_add_f32 v159, 1.0, v159
  v_rcp_f32 v156, v156
  v_rcp_f32 v157, v157
  v_rcp_f32 v158, v158
  v_rcp_f32 v159, v159
  v_fma_f32 v212, v152, v82, v83
  v_fma_f32 v213, v153, v82, v83
  v_fma_f32 v214, v154, v82, v83
  v_fma_f32 v215, v155, v82, v83
  v_mul_f32 v196, v156, v152
  v_mul_f32 v197, v157, v153
  v_mul_f32 v198, v158, v154
  v_mul_f32 v199, v159, v155
AFTP:
  v_add_u32 v244, 8192, v40
  s_setprio 2
  s_mov_b32 s59, 0
SPIN_3:
  ds_read_b32 v3, v43 offset:96
  s_add_u32 s59, s59, 1
  s_cmp_gt_u32 s59, 320000
  s_cbranch_scc1 SPD_4
  s_waitcnt lgkmcnt(0)
  v_readfirstlane_b32 s58, v3
  s_cmp_lt_u32 s58, 16843009
  s_cbranch_scc1 SPIN_3
SPD_4:
  s_waitcnt lgkmcnt(0)
  s_mov_b32 s59, 0
SPIN_5:
  ds_read_b32 v3, v43 offset:4
  ds_read_b128 v[128:131], v42 offset:0
  ds_read_b128 v[132:135], v42 offset:12096
  ds_read_b128 v[136:139], v42 offset:24192
  ds_read_b128 v[140:143], v42 offset:36288
  s_add_u32 s59, s59, 1
  s_cmp_gt_u32 s59, 320000
  s_cbranch_scc1 SPD_6
  s_waitcnt lgkmcnt(0)
  v_readfirstlane_b32 s58, v3
  s_cmp_lt_u32 s58, 16843009
  s_cbranch_scc1 SPIN_5
SPD_6:
  s_waitcnt lgkmcnt(0)
  v_fma_f32 v112, v128, v96, v112
  v_fma_f32 v113, v132, v97, v113
  v_fma_f32 v114, v136, v98, v114
  v_fma_f32 v115, v140, v99, v115
  v_cvt_pk_bf16_f32 v112, v112, v113
  v_cvt_pk_bf16_f32 v113, v114, v115
  global_store_dwordx2 v40, v[112:113], s[36:37] offset:0
  v_fma_f32 v116, v129, v100, v116
  v_fma_f32 v117, v133, v101, v117
  v_fma_f32 v118, v137, v102, v118
  v_fma_f32 v119, v141, v103, v119
  v_cvt_pk_bf16_f32 v116, v116, v117
  v_cvt_pk_bf16_f32 v117, v118, v119
  global_store_dwordx2 v40, v[116:117], s[36:37] offset:1024
  v_fma_f32 v120, v130, v104, v120
  v_fma_f32 v121, v134, v105, v121
  v_fma_f32 v122, v138, v106, v122
  v_fma_f32 v123, v142, v107, v123
  v_cvt_pk_bf16_f32 v120, v120, v121
  v_cvt_pk_bf16_f32 v121, v122, v123
  global_store_dwordx2 v244, v[120:121], s[36:37] offset:0
  v_fma_f32 v124, v131, v108, v124
  v_fma_f32 v125, v135, v109, v125
  v_fma_f32 v126, v139, v110, v126
  v_fma_f32 v127, v143, v111, v127
  v_cvt_pk_bf16_f32 v124, v124, v125
  v_cvt_pk_bf16_f32 v125, v126, v127
  global_store_dwordx2 v244, v[124:125], s[36:37] offset:1024
  ds_write_b32 v43, v2 offset:80
  s_cmp_eq_u32 s7, 3
  s_cbranch_scc1 FINC
  s_cmp_lg_u32 s53, 5
  s_cbranch_scc1 NE2
  v_add_u32 v40, 524288, v40
  s_setprio 0
  v_lshlrev_b32 v144, 16, v84
  v_and_b32 v145, s56, v84
  v_lshlrev_b32 v146, 16, v85
  v_and_b32 v147, s56, v85
  v_exp_f32 v148, v144
  v_exp_f32 v149, v145
  v_exp_f32 v150, v146
  v_exp_f32 v151, v147
  v_and_b32 v84, s56, v92
  v_lshlrev_b32 v85, 16, v92
  v_mul_f32 v84, 0xbf317218, v84
  v_add_f32 v148, 1.0, v148
  v_add_f32 v149, 1.0, v149
  v_add_f32 v150, 1.0, v150
  v_add_f32 v151, 1.0, v151
  v_rcp_f32 v148, v148
  v_rcp_f32 v149, v149
  v_rcp_f32 v150, v150
  v_rcp_f32 v151, v151
  v_fma_f32 v216, v144, v84, v85
  v_fma_f32 v217, v145, v84, v85
  v_fma_f32 v218, v146, v84, v85
  v_fma_f32 v219, v147, v84, v85
  v_mul_f32 v200, v148, v144
  v_mul_f32 v201, v149, v145
  v_mul_f32 v202, v150, v146
  v_mul_f32 v203, v151, v147
  v_lshlrev_b32 v152, 16, v86
  v_and_b32 v153, s56, v86
  v_lshlrev_b32 v154, 16, v87
  v_and_b32 v155, s56, v87
  v_exp_f32 v156, v152
  v_exp_f32 v157, v153
  v_exp_f32 v158, v154
  v_exp_f32 v159, v155
  v_and_b32 v86, s56, v94
  v_lshlrev_b32 v87, 16, v94
  v_mul_f32 v86, 0xbf317218, v86
  v_add_f32 v156, 1.0, v156
  v_add_f32 v157, 1.0, v157
  v_add_f32 v158, 1.0, v158
  v_add_f32 v159, 1.0, v159
  v_rcp_f32 v156, v156
  v_rcp_f32 v157, v157
  v_rcp_f32 v158, v158
  v_rcp_f32 v159, v159
  v_fma_f32 v220, v152, v86, v87
  v_fma_f32 v221, v153, v86, v87
  v_fma_f32 v222, v154, v86, v87
  v_fma_f32 v223, v155, v86, v87
  v_mul_f32 v204, v156, v152
  v_mul_f32 v205, v157, v153
  v_mul_f32 v206, v158, v154
  v_mul_f32 v207, v159, v155
  v_add_u32 v244, 8192, v40
  s_setprio 2
  s_mov_b32 s59, 0
SPIN_7:
  ds_read_b32 v3, v43 offset:104
  s_add_u32 s59, s59, 1
  s_cmp_gt_u32 s59, 320000
  s_cbranch_scc1 SPD_8
  s_waitcnt lgkmcnt(0)
  v_readfirstlane_b32 s58, v3
  s_cmp_lt_u32 s58, 16843009
  s_cbranch_scc1 SPIN_7
SPD_8:
  s_waitcnt lgkmcnt(0)
  s_mov_b32 s59, 0
SPIN_9:
  ds_read_b32 v3, v43 offset:12
  ds_read_b128 v[128:131], v42 offset:2048
  ds_read_b128 v[132:135], v42 offset:14144
  ds_read_b128 v[136:139], v42 offset:26240
  ds_read_b128 v[140:143], v42 offset:38336
  s_add_u32 s59, s59, 1
  s_cmp_gt_u32 s59, 320000
  s_cbranch_scc1 SPD_10
  s_waitcnt lgkmcnt(0)
  v_readfirstlane_b32 s58, v3
  s_cmp_lt_u32 s58, 16843009
  s_cbranch_scc1 SPIN_9
SPD_10:
  s_waitcnt lgkmcnt(0)
  v_fma_f32 v208, v128, v192, v208
  v_fma_f32 v209, v132, v193, v209
  v_fma_f32 v210, v136, v194, v210
  v_fma_f32 v211, v140, v195, v211
  v_cvt_pk_bf16_f32 v208, v208, v209
  v_cvt_pk_bf16_f32 v209, v210, v211
  global_store_dwordx2 v40, v[208:209], s[36:37] offset:0
  v_fma_f32 v212, v129, v196, v212
  v_fma_f32 v213, v133, v197, v213
  v_fma_f32 v214, v137, v198, v214
  v_fma_f32 v215, v141, v199, v215
  v_cvt_pk_bf16_f32 v212, v212, v213
  v_cvt_pk_bf16_f32 v213, v214, v215
  global_store_dwordx2 v40, v[212:213], s[36:37] offset:1024
  v_fma_f32 v216, v130, v200, v216
  v_fma_f32 v217, v134, v201, v217
  v_fma_f32 v218, v138, v202, v218
  v_fma_f32 v219, v142, v203, v219
  v_cvt_pk_bf16_f32 v216, v216, v217
  v_cvt_pk_bf16_f32 v217, v218, v219
  global_store_dwordx2 v244, v[216:217], s[36:37] offset:0
  v_fma_f32 v220, v131, v204, v220
  v_fma_f32 v221, v135, v205, v221
  v_fma_f32 v222, v139, v206, v222
  v_fma_f32 v223, v143, v207, v223
  v_cvt_pk_bf16_f32 v220, v220, v221
  v_cvt_pk_bf16_f32 v221, v222, v223
  global_store_dwordx2 v244, v[220:221], s[36:37] offset:1024
  ds_write_b32 v43, v2 offset:88
NE2:
  s_lshl3_add_u32 s58, s2, s3
  s_cmp_lg_u32 s58, 5
  s_cbranch_scc1 FIN
  s_mov_b32 s59, 0
ARL:
  global_load_dword v16, v52, s[40:41] offset:8 sc1
  global_load_dword v17, v52, s[40:41] offset:1032 sc1
  global_load_dword v18, v52, s[40:41] offset:2056 sc1
  global_load_dword v19, v52, s[40:41] offset:3080 sc1
  s_add_u32 s59, s59, 1
  s_cmp_gt_u32 s59, 20000
  s_waitcnt vmcnt(0)
  v_min3_u32 v20, v16, v17, v11
  v_max3_u32 v21, v16, v17, v11
  v_min3_u32 v20, v18, v19, v20
  v_max3_u32 v21, v18, v19, v21
  v_cmp_ne_u32 vcc, v20, v21
  s_cbranch_scc1 ARD
  s_cbranch_vccnz ARL
ARD:
  v_mov_b32 v16, 4227072
  global_store_dword v16, v11, s[40:41] sc1
  s_branch FIN
FINS:
  v_lshrrev_b32 v16, 5, v0
  v_lshl_add_u32 v17, v16, 4, v1
  ds_read_b64 v[20:21], v17 offset:32
  v_bfe_u32 v13, v0, 3, 2
  s_lshl_b32 s45, s4, 3
  v_lshl_add_u32 v18, v13, 1, s45
  v_and_b32 v19, 31, v0
  s_lshl4_add_u32 s44, s4, 4259840
  v_lshl_add_u32 v16, v16, 11, s44
  v_lshl_add_u32 v45, v19, 12, v16
  v_add_u32 v46, 131072, v45
  v_min_u32 v19, 21, v19
  v_lshl_add_u32 v47, v19, 12, v16
  v_add_u32 v47, 262144, v47
  s_mov_b32 s44, 0x32765410
  s_waitcnt lgkmcnt(0)
  v_lshrrev_b32 v16, 6, v21
  v_and_b32 v16, 28, v16
  v_lshrrev_b32 v16, v16, s44
  v_bfe_u32 v17, v16, 2, 1
  v_cmp_eq_u32 s[100:101], s5, v17
  v_lshl_add_u32 v48, v21, 10, v18
  v_mul_u32_u24 v18, 4608, v13
  v_lshl_add_u32 v18, v21, 1, v18
  v_and_b32 v16, 3, v16
  v_lshl_add_u32 v169, v16, 2, v1
  v_mul_u32_u24 v17, 12096, v13
  v_lshl_add_u32 v16, v16, 10, v17
  v_and_b32 v17, 0xf8, v21
  v_and_b32 v19, 4, v21
  v_lshl_add_u32 v17, v19, 6, v17
  v_and_b32 v19, 2, v21
  v_lshl_add_u32 v17, v19, 8, v17
  v_and_b32 v19, 1, v21
  v_lshl_add_u32 v17, v19, 2, v17
  v_add_u32 v168, v16, v17
  s_cmp_eq_u64 s[100:101], 0
  s_cbranch_scc1 FNO
  v_ashrrev_i32 v16, 31, v20
  v_not_b32 v16, v16
  v_or_b32 v16, 0x80000000, v16
  v_xor_b32 v16, v16, v20
  v_and_b32 v16, s56, v16
  v_mul_f32 v163, 0xbfb8aa3b, v16
  v_exp_f32 v163, v163
  s_mov_b32 s54, 0x0c0c0400
  s_mov_b32 s55, 0x04000c0c
  v_add_f32 v163, 1.0, v163
  v_rcp_f32 v163, v163
  s_mov_b32 s52, 0
  s_mov_b32 s44, 0x01010101
  s_mov_b32 s45, 0x01010101
  v_mul_f32 v163, 0xbfb8aa3b, v163
  ds_read_b32 v16, v1 offset:28
  s_waitcnt lgkmcnt(0)
  v_readfirstlane_b32 s58, v16
  s_cmp_eq_u32 s58, 16843009
  s_cselect_b32 s58, 12, 8
  s_cmp_gt_u32 s6, 85
  s_cselect_b32 s58, s58, 8
  v_add_u32 v16, s58, v1
  s_mov_b32 s59, 0
SPIN_11:
  ds_read_b32 v3, v16 offset:4
  s_add_u32 s59, s59, 1
  s_cmp_gt_u32 s59, 320000
  s_cbranch_scc1 SPD_12
  s_waitcnt lgkmcnt(0)
  v_readfirstlane_b32 s58, v3
  s_cmp_lt_u32 s58, 16843009
  s_cbranch_scc1 SPIN_11
SPD_12:
  s_waitcnt lgkmcnt(0)
  s_setprio 3
  global_load_ushort v161, v48, s[8:9]
  ds_read_u16 v160, v18 offset:48896
  s_mov_b64 exec, s[100:101]
  global_load_dwordx4 v[24:27], v45, s[40:41] sc1
  global_load_dwordx4 v[28:31], v46, s[40:41] sc1
  global_load_dwordx4 v[32:35], v47, s[40:41] sc1
  s_mov_b64 exec, -1
FNO:
  s_cmp_eq_u32 s5, 0
  s_cbranch_scc1 AFTP
  s_waitcnt vmcnt(0)
FINC:
  s_mov_b64 exec, s[100:101]
  s_cbranch_execz FIN
  s_setprio 3
  s_waitcnt vmcnt(4) lgkmcnt(0)
PCHK:
  s_add_u32 s52, s52, 1
  v_perm_b32 v16, v25, v24, s54
  v_perm_b32 v17, v27, v26, s55
  v_perm_b32 v18, v29, v28, s54
  v_perm_b32 v19, v31, v30, s55
  v_perm_b32 v20, v33, v32, s54
  v_perm_b32 v21, v35, v34, s55
  v_or_b32 v16, v16, v17
  v_or_b32 v18, v18, v19
  v_or_b32 v20, v20, v21
  v_min3_u32 v17, v16, v18, v20
  v_max3_u32 v19, v16, v18, v20
  v_min_u32 v17, v17, v11
  v_max_u32 v19, v19, v11
  s_cmp_gt_u32 s52, 20000
  v_cmp_ne_u32 vcc, v17, v19
  s_cbranch_scc1 PDONE
  s_and_b64 exec, exec, vcc
  s_cbranch_execz PDONE
  global_load_dwordx4 v[24:27], v45, s[40:41] sc1
  global_load_dwordx4 v[28:31], v46, s[40:41] sc1
  global_load_dwordx4 v[32:35], v47, s[40:41] sc1
  s_waitcnt vmcnt(0)
  s_branch PCHK
PDONE:
  s_mov_b32 exec_lo, 0x3fffff
  s_mov_b32 exec_hi, 0x3fffff
  v_add_f32 v24, v24, v32
  v_add_f32 v26, v26, v34
  v_add_f32 v25, v25, v33
  v_add_f32 v27, v27, v35
  s_mov_b64 exec, -1
  v_add_f32 v24, v24, v28
  v_add_f32 v26, v26, v30
  v_add_f32 v25, v25, v29
  v_add_f32 v27, v27, v31
  v_permlane16_swap_b32 v24, v26
  v_lshlrev_b32 v160, 16, v160
  v_permlane16_swap_b32 v25, v27
  v_add_f32 v24, v24, v26
  v_add_f32 v25, v25, v27
  s_nop 0
  v_add_f32_dpp v24, v24, v24 row_ror:8 row_mask:0xf bank_mask:0x3
  v_lshlrev_b32 v161, 16, v161
  s_nop 0
  v_add_f32_dpp v24, v25, v25 row_ror:8 row_mask:0xf bank_mask:0xc
  s_mov_b32 s59, 0
  s_nop 0
  v_add_f32_dpp v24, v24, v24 row_half_mirror row_mask:0xf bank_mask:0xf
  s_nop 1
  v_add_f32_dpp v24, v24, v24 quad_perm:[1,0,3,2] row_mask:0xf bank_mask:0xf
  s_nop 1
  v_add_f32_dpp v24, v24, v24 quad_perm:[2,3,0,1] row_mask:0xf bank_mask:0xf
  s_and_b64 exec, s[44:45], s[100:101]
FSP:
  ds_read_b32 v3, v169 offset:80
  ds_read_b32 v26, v168
  v_fma_f32 v27, v24, v163, v160
  v_exp_f32 v25, v27
  s_add_u32 s59, s59, 1
  s_cmp_gt_u32 s59, 320000
  v_add_f32 v25, 1.0, v25
  v_rcp_f32 v25, v25
  s_waitcnt lgkmcnt(0)
  v_cmp_eq_u32 vcc, 0, v3
  v_mul_f32 v25, v25, v27
  s_cbranch_scc1 FSD
  s_cbranch_vccnz FSP
FSD:
  v_fma_f32 v26, v26, v25, v161
  v_cvt_pk_bf16_f32 v26, v26, v26
  global_store_short v48, v26, s[36:37]
FIN:
  s_endpgm
.p2align 12
KG0:
  s_setprio 1
  s_mul_i32 s50, s7, 12096
  s_mul_i32 s51, s7, 3072
  v_and_b32 v12, 15, v0
  s_mov_b32 m0, s50
  v_and_b32 v13, 48, v0
  v_mov_b32 v10, 0x3f80
  ds_write_addtid_b32 v4 offset:7200
  v_add_u32 v8, s50, v13
  ds_write_addtid_b32 v10 offset:0
  s_movk_i32 s49, 288
  v_cmp_lt_u32 vcc, 9, v12
  v_mad_u32_u24 v210, v12, s49, v8
  v_min_u32 v9, 8, v12
  v_addc_co_u32 v9, vcc, 0, v9, vcc
  v_mad_u32_u24 v211, v9, s49, v8
  v_mov_b32 v1, 79104
  v_mov_b32 v2, 1
  v_lshl_add_u32 v12, v0, 4, v1
  v_add_u32 v13, s51, v12
  v_mov_b64 v[188:189], 0
  v_mov_b64 v[190:191], 0
  v_mov_b64 v[192:193], 0
  v_mov_b64 v[194:195], 0
  v_mov_b64 v[196:197], 0
  v_mov_b64 v[198:199], 0
  v_mov_b64 v[140:141], 0
  v_mov_b64 v[142:143], 0
  v_mov_b64 v[144:145], 0
  v_mov_b64 v[146:147], 0
  v_mov_b64 v[148:149], 0
  v_mov_b64 v[150:151], 0
  v_mov_b64 v[152:153], 0
  v_mov_b64 v[154:155], 0
  v_mov_b64 v[156:157], 0
  v_mov_b64 v[158:159], 0
  v_mov_b64 v[160:161], 0
  v_mov_b64 v[162:163], 0
  v_mov_b64 v[164:165], 0
  v_mov_b64 v[166:167], 0
  v_mov_b64 v[168:169], 0
  v_mov_b64 v[170:171], 0
  s_waitcnt lgkmcnt(0)
  s_lshl_b32 s45, s44, 16
  s_and_b32 s44, s44, s56
  s_lshl_b32 s47, s46, 16
  s_and_b32 s46, s46, s56
  s_bitcmp1_b32 s42, 0
  s_cselect_b32 s44, s44, s45
  s_cselect_b32 s46, s46, s47
  v_mov_b32 v8, 0x3fb8aa3b
  v_mul_f32 v8, s44, v8
  v_exp_f32 v8, v8
  s_mov_b32 s52, 0x01000c0c
  s_cmp_eq_u32 s3, s3
  v_cvt_pk_bf16_f32 v8, v8, v8
  v_and_b32 v8, s56, v8
  v_mul_f32 v10, 0x3fb8aa3b, v8
  v_mul_f32 v11, 0x3e22f983, v8
  v_mul_f32 v8, 0x3ef5fdf0, v8
  v_mov_b32 v14, 0x3ef5fdf0
  s_mov_b64 exec, 1
  v_mul_f32 v188, s46, v14
  s_mov_b64 exec, -1
  s_waitcnt vmcnt(0)
KLOOP:
  v_perm_b32 v52, v200, v200, s52
  v_perm_b32 v53, v201, v201, s52
  v_perm_b32 v54, v202, v202, s52
  v_perm_b32 v55, v203, v203, s52
  v_perm_b32 v56, v204, v204, s52
  v_perm_b32 v57, v205, v205, s52
  v_mul_f32 v52, v52, v10
  v_mul_f32 v53, v53, v11
  v_pk_mul_f32 v[58:59], v[56:57], v[54:55] op_sel:[0,0] op_sel_hi:[0,1] neg_hi:[0,1]
  v_mul_f32 v60, 0x41800000, v52
  v_mul_f32 v61, 0x41800000, v53
  v_mul_f32 v62, 0x43800000, v52
  v_mul_f32 v63, 0x43800000, v53
  v_pk_fma_f32 v[58:59], v[56:57], v[54:55], v[58:59] op_sel:[1,1,0] op_sel_hi:[1,0,1] neg_lo:[0,1,0] neg_hi:[0,1,0]
  v_fract_f32 v61, v61
  v_fract_f32 v53, v53
  v_fract_f32 v63, v63
  v_exp_f32 v60, v60
  v_cos_f32 v48, v61
  v_sin_f32 v49, v61
  v_exp_f32 v52, v52
  v_cos_f32 v18, v53
  v_sin_f32 v19, v53
  v_exp_f32 v62, v62
  v_cos_f32 v50, v63
  v_sin_f32 v51, v63
  v_pk_mul_f32 v[58:59], v[58:59], v[8:9] op_sel_hi:[1,0]
  v_pk_mul_f32 v[48:49], v[48:49], v[60:61] op_sel_hi:[1,0]
  v_pk_mul_f32 v[18:19], v[18:19], v[52:53] op_sel_hi:[1,0]
  v_pk_mul_f32 v[50:51], v[50:51], v[62:63] op_sel_hi:[1,0]
  v_cvt_pk_bf16_f32 v100, v58, v59
  v_pk_mul_f32 v[64:65], v[58:59], v[48:49] op_sel:[0,0] op_sel_hi:[0,1] neg_hi:[0,1]
  v_pk_fma_f32 v[64:65], v[58:59], v[48:49], v[64:65] op_sel:[1,1,0] op_sel_hi:[1,0,1]
  v_cvt_pk_bf16_f32 v101, v64, v65
  v_pk_mul_f32 v[58:59], v[64:65], v[48:49] op_sel:[0,0] op_sel_hi:[0,1] neg_hi:[0,1]
  v_pk_fma_f32 v[58:59], v[64:65], v[48:49], v[58:59] op_sel:[1,1,0] op_sel_hi:[1,0,1]
  v_cvt_pk_bf16_f32 v102, v58, v59
  v_pk_mul_f32 v[64:65], v[58:59], v[48:49] op_sel:[0,0] op_sel_hi:[0,1] neg_hi:[0,1]
  v_pk_fma_f32 v[64:65], v[58:59], v[48:49], v[64:65] op_sel:[1,1,0] op_sel_hi:[1,0,1]
  v_cvt_pk_bf16_f32 v103, v64, v65
  v_pk_mul_f32 v[58:59], v[64:65], v[48:49] op_sel:[0,0] op_sel_hi:[0,1] neg_hi:[0,1]
  v_pk_fma_f32 v[58:59], v[64:65], v[48:49], v[58:59] op_sel:[1,1,0] op_sel_hi:[1,0,1]
  v_cvt_pk_bf16_f32 v104, v58, v59
  v_pk_mul_f32 v[64:65], v[58:59], v[48:49] op_sel:[0,0] op_sel_hi:[0,1] neg_hi:[0,1]
  v_pk_fma_f32 v[64:65], v[58:59], v[48:49], v[64:65] op_sel:[1,1,0] op_sel_hi:[1,0,1]
  v_cvt_pk_bf16_f32 v105, v64, v65
  v_pk_mul_f32 v[58:59], v[64:65], v[48:49] op_sel:[0,0] op_sel_hi:[0,1] neg_hi:[0,1]
  v_pk_fma_f32 v[58:59], v[64:65], v[48:49], v[58:59] op_sel:[1,1,0] op_sel_hi:[1,0,1]
  v_cvt_pk_bf16_f32 v106, v58, v59
  v_pk_mul_f32 v[64:65], v[58:59], v[48:49] op_sel:[0,0] op_sel_hi:[0,1] neg_hi:[0,1]
  v_pk_fma_f32 v[64:65], v[58:59], v[48:49], v[64:65] op_sel:[1,1,0] op_sel_hi:[1,0,1]
  v_cvt_pk_bf16_f32 v107, v64, v65
  s_waitcnt lgkmcnt(0)
  v_mfma_f32_16x16x32_bf16 v[196:199], v[156:159], v[140:143], v[196:199]
  s_nop 0
  ds_write_addtid_b32 v100 offset:7488
  ds_write_addtid_b32 v101 offset:7776
  v_mfma_f32_16x16x32_bf16 v[196:199], v[160:163], v[144:147], v[196:199]
  s_nop 0
  ds_write_addtid_b32 v102 offset:8064
  ds_write_addtid_b32 v103 offset:8352
  v_mfma_f32_16x16x32_bf16 v[196:199], v[164:167], v[148:151], v[196:199]
  s_nop 0
  ds_write_addtid_b32 v104 offset:8640
  ds_write_addtid_b32 v105 offset:8928
  v_mfma_f32_16x16x32_bf16 v[196:199], v[168:171], v[152:155], v[196:199]
  s_nop 0
  ds_write_addtid_b32 v106 offset:9216
  ds_write_addtid_b32 v107 offset:9504
  v_pk_mul_f32 v[58:59], v[64:65], v[48:49] op_sel:[0,0] op_sel_hi:[0,1] neg_hi:[0,1]
  v_pk_fma_f32 v[58:59], v[64:65], v[48:49], v[58:59] op_sel:[1,1,0] op_sel_hi:[1,0,1]
  v_cvt_pk_bf16_f32 v108, v58, v59
  v_pk_mul_f32 v[64:65], v[58:59], v[48:49] op_sel:[0,0] op_sel_hi:[0,1] neg_hi:[0,1]
  v_pk_fma_f32 v[64:65], v[58:59], v[48:49], v[64:65] op_sel:[1,1,0] op_sel_hi:[1,0,1]
  v_cvt_pk_bf16_f32 v109, v64, v65
  v_pk_mul_f32 v[58:59], v[64:65], v[48:49] op_sel:[0,0] op_sel_hi:[0,1] neg_hi:[0,1]
  v_pk_fma_f32 v[58:59], v[64:65], v[48:49], v[58:59] op_sel:[1,1,0] op_sel_hi:[1,0,1]
  v_cvt_pk_bf16_f32 v110, v58, v59
  v_pk_mul_f32 v[64:65], v[58:59], v[48:49] op_sel:[0,0] op_sel_hi:[0,1] neg_hi:[0,1]
  v_pk_fma_f32 v[64:65], v[58:59], v[48:49], v[64:65] op_sel:[1,1,0] op_sel_hi:[1,0,1]
  v_cvt_pk_bf16_f32 v111, v64, v65
  v_pk_mul_f32 v[58:59], v[64:65], v[48:49] op_sel:[0,0] op_sel_hi:[0,1] neg_hi:[0,1]
  v_pk_fma_f32 v[58:59], v[64:65], v[48:49], v[58:59] op_sel:[1,1,0] op_sel_hi:[1,0,1]
  v_cvt_pk_bf16_f32 v112, v58, v59
  v_pk_mul_f32 v[64:65], v[58:59], v[48:49] op_sel:[0,0] op_sel_hi:[0,1] neg_hi:[0,1]
  v_pk_fma_f32 v[64:65], v[58:59], v[48:49], v[64:65] op_sel:[1,1,0] op_sel_hi:[1,0,1]
  v_cvt_pk_bf16_f32 v113, v64, v65
  v_pk_mul_f32 v[58:59], v[64:65], v[48:49] op_sel:[0,0] op_sel_hi:[0,1] neg_hi:[0,1]
  v_pk_fma_f32 v[58:59], v[64:65], v[48:49], v[58:59] op_sel:[1,1,0] op_sel_hi:[1,0,1]
  v_cvt_pk_bf16_f32 v114, v58, v59
  v_pk_mul_f32 v[64:65], v[58:59], v[48:49] op_sel:[0,0] op_sel_hi:[0,1] neg_hi:[0,1]
  v_pk_fma_f32 v[64:65], v[58:59], v[48:49], v[64:65] op_sel:[1,1,0] op_sel_hi:[1,0,1]
  v_cvt_pk_bf16_f32 v115, v64, v65
  ds_write_addtid_b32 v108 offset:9792
  ds_write_addtid_b32 v109 offset:10080
  ds_write_addtid_b32 v110 offset:10368
  ds_write_addtid_b32 v111 offset:10656
  ds_write_addtid_b32 v112 offset:10944
  ds_write_addtid_b32 v113 offset:11232
  ds_write_addtid_b32 v114 offset:11520
  ds_write_addtid_b32 v115 offset:11808
  ds_read_b128 v[140:143], v210 offset:7488
  ds_read_b128 v[144:147], v210 offset:7552
  ds_read_b128 v[148:151], v210 offset:7616
  ds_read_b128 v[152:155], v210 offset:7680
  v_cvt_pk_bf16_f32 v100, v18, v19
  v_pk_mul_f32 v[20:21], v[18:19], v[18:19] op_sel:[0,0] op_sel_hi:[0,1]
  v_pk_fma_f32 v[20:21], v[18:19], v[18:19], v[20:21] op_sel:[1,1,0] op_sel_hi:[1,0,1] neg_lo:[0,1,0]
  v_cvt_pk_bf16_f32 v101, v20, v21
  v_pk_mul_f32 v[22:23], v[20:21], v[18:19] op_sel:[0,0] op_sel_hi:[0,1]
  v_pk_fma_f32 v[22:23], v[20:21], v[18:19], v[22:23] op_sel:[1,1,0] op_sel_hi:[1,0,1] neg_lo:[0,1,0]
  v_cvt_pk_bf16_f32 v102, v22, v23
  v_pk_mul_f32 v[24:25], v[20:21], v[20:21] op_sel:[0,0] op_sel_hi:[0,1]
  v_pk_fma_f32 v[24:25], v[20:21], v[20:21], v[24:25] op_sel:[1,1,0] op_sel_hi:[1,0,1] neg_lo:[0,1,0]
  v_cvt_pk_bf16_f32 v103, v24, v25
  v_pk_mul_f32 v[26:27], v[22:23], v[20:21] op_sel:[0,0] op_sel_hi:[0,1]
  v_pk_fma_f32 v[26:27], v[22:23], v[20:21], v[26:27] op_sel:[1,1,0] op_sel_hi:[1,0,1] neg_lo:[0,1,0]
  v_cvt_pk_bf16_f32 v104, v26, v27
  v_pk_mul_f32 v[28:29], v[22:23], v[22:23] op_sel:[0,0] op_sel_hi:[0,1]
  v_pk_fma_f32 v[28:29], v[22:23], v[22:23], v[28:29] op_sel:[1,1,0] op_sel_hi:[1,0,1] neg_lo:[0,1,0]
  v_cvt_pk_bf16_f32 v105, v28, v29
  v_pk_mul_f32 v[30:31], v[24:25], v[22:23] op_sel:[0,0] op_sel_hi:[0,1]
  v_pk_fma_f32 v[30:31], v[24:25], v[22:23], v[30:31] op_sel:[1,1,0] op_sel_hi:[1,0,1] neg_lo:[0,1,0]
  v_cvt_pk_bf16_f32 v106, v30, v31
  v_pk_mul_f32 v[32:33], v[24:25], v[24:25] op_sel:[0,0] op_sel_hi:[0,1]
  v_pk_fma_f32 v[32:33], v[24:25], v[24:25], v[32:33] op_sel:[1,1,0] op_sel_hi:[1,0,1] neg_lo:[0,1,0]
  v_cvt_pk_bf16_f32 v107, v32, v33
  ds_write_addtid_b32 v100 offset:288
  ds_write_addtid_b32 v101 offset:576
  ds_write_addtid_b32 v102 offset:864
  ds_write_addtid_b32 v103 offset:1152
  ds_write_addtid_b32 v104 offset:1440
  ds_write_addtid_b32 v105 offset:1728
  ds_write_addtid_b32 v106 offset:2016
  ds_write_addtid_b32 v107 offset:2304
  s_cbranch_scc1 KNT
  ds_read_b32 v3, v1 offset:24
  ds_read_b128 v[212:215], v13 offset:512
  ds_read_b128 v[216:219], v13 offset:1536
  ds_read_b128 v[220:223], v13 offset:2560
  ds_read_b128 v[224:227], v12 offset:12800
  ds_read_b128 v[228:231], v12 offset:13824
  ds_read_b128 v[232:235], v12 offset:14848
  ds_read_b128 v[236:239], v12 offset:15872
  ds_read_b128 v[240:243], v12 offset:16896
KNT:
  v_pk_mul_f32 v[34:35], v[26:27], v[24:25] op_sel:[0,0] op_sel_hi:[0,1]
  v_pk_fma_f32 v[34:35], v[26:27], v[24:25], v[34:35] op_sel:[1,1,0] op_sel_hi:[1,0,1] neg_lo:[0,1,0]
  v_cvt_pk_bf16_f32 v108, v34, v35
  v_pk_mul_f32 v[36:37], v[26:27], v[26:27] op_sel:[0,0] op_sel_hi:[0,1]
  v_pk_fma_f32 v[36:37], v[26:27], v[26:27], v[36:37] op_sel:[1,1,0] op_sel_hi:[1,0,1] neg_lo:[0,1,0]
  v_cvt_pk_bf16_f32 v109, v36, v37
  v_pk_mul_f32 v[38:39], v[28:29], v[26:27] op_sel:[0,0] op_sel_hi:[0,1]
  v_pk_fma_f32 v[38:39], v[28:29], v[26:27], v[38:39] op_sel:[1,1,0] op_sel_hi:[1,0,1] neg_lo:[0,1,0]
  v_cvt_pk_bf16_f32 v110, v38, v39
  v_pk_mul_f32 v[40:41], v[28:29], v[28:29] op_sel:[0,0] op_sel_hi:[0,1]
  v_pk_fma_f32 v[40:41], v[28:29], v[28:29], v[40:41] op_sel:[1,1,0] op_sel_hi:[1,0,1] neg_lo:[0,1,0]
  v_cvt_pk_bf16_f32 v111, v40, v41
  v_pk_mul_f32 v[42:43], v[30:31], v[28:29] op_sel:[0,0] op_sel_hi:[0,1]
  v_pk_fma_f32 v[42:43], v[30:31], v[28:29], v[42:43] op_sel:[1,1,0] op_sel_hi:[1,0,1] neg_lo:[0,1,0]
  v_cvt_pk_bf16_f32 v112, v42, v43
  v_pk_mul_f32 v[44:45], v[30:31], v[30:31] op_sel:[0,0] op_sel_hi:[0,1]
  v_pk_fma_f32 v[44:45], v[30:31], v[30:31], v[44:45] op_sel:[1,1,0] op_sel_hi:[1,0,1] neg_lo:[0,1,0]
  v_cvt_pk_bf16_f32 v113, v44, v45
  v_pk_mul_f32 v[46:47], v[32:33], v[30:31] op_sel:[0,0] op_sel_hi:[0,1]
  v_pk_fma_f32 v[46:47], v[32:33], v[30:31], v[46:47] op_sel:[1,1,0] op_sel_hi:[1,0,1] neg_lo:[0,1,0]
  v_cvt_pk_bf16_f32 v114, v46, v47
  v_pk_mul_f32 v[116:117], v[50:51], v[50:51] op_sel:[0,0] op_sel_hi:[0,1]
  v_pk_fma_f32 v[116:117], v[50:51], v[50:51], v[116:117] op_sel:[1,1,0] op_sel_hi:[1,0,1] neg_lo:[0,1,0]
  v_cvt_pk_bf16_f32 v115, v116, v117
  ds_write_addtid_b32 v108 offset:2592
  ds_write_addtid_b32 v109 offset:2880
  ds_write_addtid_b32 v110 offset:3168
  ds_write_addtid_b32 v111 offset:3456
  ds_write_addtid_b32 v112 offset:3744
  ds_write_addtid_b32 v113 offset:4032
  ds_write_addtid_b32 v114 offset:4320
  ds_write_addtid_b32 v115 offset:6912
  ds_read_b128 v[156:159], v210 offset:0
  ds_read_b128 v[160:163], v210 offset:64
  ds_read_b128 v[164:167], v210 offset:128
  ds_read_b128 v[168:171], v210 offset:192
  v_cvt_pk_bf16_f32 v100, v50, v51
  v_pk_mul_f32 v[70:71], v[50:51], v[20:21] op_sel:[0,0] op_sel_hi:[0,1]
  v_pk_fma_f32 v[70:71], v[50:51], v[20:21], v[70:71] op_sel:[1,1,0] op_sel_hi:[1,0,1] neg_lo:[0,1,0]
  v_cvt_pk_bf16_f32 v101, v70, v71
  v_pk_mul_f32 v[72:73], v[50:51], v[24:25] op_sel:[0,0] op_sel_hi:[0,1]
  v_pk_fma_f32 v[72:73], v[50:51], v[24:25], v[72:73] op_sel:[1,1,0] op_sel_hi:[1,0,1] neg_lo:[0,1,0]
  v_cvt_pk_bf16_f32 v102, v72, v73
  v_pk_mul_f32 v[74:75], v[50:51], v[28:29] op_sel:[0,0] op_sel_hi:[0,1]
  v_pk_fma_f32 v[74:75], v[50:51], v[28:29], v[74:75] op_sel:[1,1,0] op_sel_hi:[1,0,1] neg_lo:[0,1,0]
  v_cvt_pk_bf16_f32 v103, v74, v75
  v_pk_mul_f32 v[76:77], v[50:51], v[32:33] op_sel:[0,0] op_sel_hi:[0,1]
  v_pk_fma_f32 v[76:77], v[50:51], v[32:33], v[76:77] op_sel:[1,1,0] op_sel_hi:[1,0,1] neg_lo:[0,1,0]
  v_cvt_pk_bf16_f32 v104, v76, v77
  v_pk_mul_f32 v[78:79], v[50:51], v[36:37] op_sel:[0,0] op_sel_hi:[0,1]
  v_pk_fma_f32 v[78:79], v[50:51], v[36:37], v[78:79] op_sel:[1,1,0] op_sel_hi:[1,0,1] neg_lo:[0,1,0]
  v_cvt_pk_bf16_f32 v105, v78, v79
  v_pk_mul_f32 v[80:81], v[50:51], v[40:41] op_sel:[0,0] op_sel_hi:[0,1]
  v_pk_fma_f32 v[80:81], v[50:51], v[40:41], v[80:81] op_sel:[1,1,0] op_sel_hi:[1,0,1] neg_lo:[0,1,0]
  v_cvt_pk_bf16_f32 v106, v80, v81
  v_pk_mul_f32 v[82:83], v[50:51], v[44:45] op_sel:[0,0] op_sel_hi:[0,1]
  v_pk_fma_f32 v[82:83], v[50:51], v[44:45], v[82:83] op_sel:[1,1,0] op_sel_hi:[1,0,1] neg_lo:[0,1,0]
  v_cvt_pk_bf16_f32 v107, v82, v83
  s_waitcnt lgkmcnt(0)
  v_mfma_f32_16x16x32_bf16 v[188:191], v[156:159], v[140:143], v[188:191]
  s_nop 0
  ds_write_addtid_b32 v100 offset:4608
  ds_write_addtid_b32 v101 offset:4896
  v_mfma_f32_16x16x32_bf16 v[188:191], v[160:163], v[144:147], v[188:191]
  s_nop 0
  ds_write_addtid_b32 v102 offset:5184
  ds_write_addtid_b32 v103 offset:5472
  v_mfma_f32_16x16x32_bf16 v[188:191], v[164:167], v[148:151], v[188:191]
  s_nop 0
  ds_write_addtid_b32 v104 offset:5760
  ds_write_addtid_b32 v105 offset:6048
  v_mfma_f32_16x16x32_bf16 v[188:191], v[168:171], v[152:155], v[188:191]
  s_nop 0
  ds_write_addtid_b32 v106 offset:6336
  ds_write_addtid_b32 v107 offset:6624
  ds_read_b128 v[172:175], v211 offset:4608
  ds_read_b128 v[176:179], v211 offset:4672
  ds_read_b128 v[180:183], v211 offset:4736
  ds_read_b128 v[184:187], v211 offset:4800
  v_pk_mul_f32 v[84:85], v[116:117], v[24:25] op_sel:[0,0] op_sel_hi:[0,1]
  v_pk_fma_f32 v[84:85], v[116:117], v[24:25], v[84:85] op_sel:[1,1,0] op_sel_hi:[1,0,1] neg_lo:[0,1,0]
  v_cvt_pk_bf16_f32 v108, v84, v85
  v_pk_mul_f32 v[86:87], v[116:117], v[32:33] op_sel:[0,0] op_sel_hi:[0,1]
  v_pk_fma_f32 v[86:87], v[116:117], v[32:33], v[86:87] op_sel:[1,1,0] op_sel_hi:[1,0,1] neg_lo:[0,1,0]
  v_cvt_pk_bf16_f32 v109, v86, v87
  v_pk_mul_f32 v[88:89], v[116:117], v[40:41] op_sel:[0,0] op_sel_hi:[0,1]
  v_pk_fma_f32 v[88:89], v[116:117], v[40:41], v[88:89] op_sel:[1,1,0] op_sel_hi:[1,0,1] neg_lo:[0,1,0]
  v_cvt_pk_bf16_f32 v110, v88, v89
  v_pk_mul_f32 v[90:91], v[116:117], v[48:49] op_sel:[0,0] op_sel_hi:[0,1]
  v_pk_fma_f32 v[90:91], v[116:117], v[48:49], v[90:91] op_sel:[1,1,0] op_sel_hi:[1,0,1] neg_lo:[0,1,0]
  v_cvt_pk_bf16_f32 v111, v90, v91
  v_pk_mul_f32 v[92:93], v[84:85], v[50:51] op_sel:[0,0] op_sel_hi:[0,1]
  v_pk_fma_f32 v[92:93], v[84:85], v[50:51], v[92:93] op_sel:[1,1,0] op_sel_hi:[1,0,1] neg_lo:[0,1,0]
  v_cvt_pk_bf16_f32 v112, v92, v93
  v_pk_mul_f32 v[94:95], v[86:87], v[50:51] op_sel:[0,0] op_sel_hi:[0,1]
  v_pk_fma_f32 v[94:95], v[86:87], v[50:51], v[94:95] op_sel:[1,1,0] op_sel_hi:[1,0,1] neg_lo:[0,1,0]
  v_cvt_pk_bf16_f32 v113, v94, v95
  v_pk_mul_f32 v[96:97], v[88:89], v[50:51] op_sel:[0,0] op_sel_hi:[0,1]
  v_pk_fma_f32 v[96:97], v[88:89], v[50:51], v[96:97] op_sel:[1,1,0] op_sel_hi:[1,0,1] neg_lo:[0,1,0]
  v_cvt_pk_bf16_f32 v114, v96, v97
  v_pk_mul_f32 v[98:99], v[90:91], v[50:51] op_sel:[0,0] op_sel_hi:[0,1]
  v_pk_fma_f32 v[98:99], v[90:91], v[50:51], v[98:99] op_sel:[1,1,0] op_sel_hi:[1,0,1] neg_lo:[0,1,0]
  v_cvt_pk_bf16_f32 v115, v98, v99
  s_waitcnt lgkmcnt(0)
  v_mfma_f32_16x16x32_bf16 v[192:195], v[172:175], v[140:143], v[192:195]
  s_nop 0
  ds_write_addtid_b32 v108 offset:7488
  ds_write_addtid_b32 v109 offset:7776
  v_mfma_f32_16x16x32_bf16 v[192:195], v[176:179], v[144:147], v[192:195]
  s_nop 0
  ds_write_addtid_b32 v110 offset:8064
  ds_write_addtid_b32 v111 offset:8352
  v_mfma_f32_16x16x32_bf16 v[192:195], v[180:183], v[148:151], v[192:195]
  s_nop 0
  ds_write_addtid_b32 v112 offset:8640
  ds_write_addtid_b32 v113 offset:8928
  v_mfma_f32_16x16x32_bf16 v[192:195], v[184:187], v[152:155], v[192:195]
  s_nop 0
  ds_write_addtid_b32 v114 offset:9216
  ds_write_addtid_b32 v115 offset:9504
  v_pk_mul_f32 v[84:85], v[86:87], v[116:117] op_sel:[0,0] op_sel_hi:[0,1]
  v_pk_fma_f32 v[84:85], v[86:87], v[116:117], v[84:85] op_sel:[1,1,0] op_sel_hi:[1,0,1] neg_lo:[0,1,0]
  v_cvt_pk_bf16_f32 v100, v84, v85
  v_pk_mul_f32 v[88:89], v[90:91], v[116:117] op_sel:[0,0] op_sel_hi:[0,1]
  v_pk_fma_f32 v[88:89], v[90:91], v[116:117], v[88:89] op_sel:[1,1,0] op_sel_hi:[1,0,1] neg_lo:[0,1,0]
  v_cvt_pk_bf16_f32 v101, v88, v89
  v_pk_mul_f32 v[92:93], v[94:95], v[116:117] op_sel:[0,0] op_sel_hi:[0,1]
  v_pk_fma_f32 v[92:93], v[94:95], v[116:117], v[92:93] op_sel:[1,1,0] op_sel_hi:[1,0,1] neg_lo:[0,1,0]
  v_cvt_pk_bf16_f32 v102, v92, v93
  v_pk_mul_f32 v[96:97], v[98:99], v[116:117] op_sel:[0,0] op_sel_hi:[0,1]
  v_pk_fma_f32 v[96:97], v[98:99], v[116:117], v[96:97] op_sel:[1,1,0] op_sel_hi:[1,0,1] neg_lo:[0,1,0]
  v_cvt_pk_bf16_f32 v103, v96, v97
  v_pk_mul_f32 v[86:87], v[84:85], v[116:117] op_sel:[0,0] op_sel_hi:[0,1]
  v_pk_fma_f32 v[86:87], v[84:85], v[116:117], v[86:87] op_sel:[1,1,0] op_sel_hi:[1,0,1] neg_lo:[0,1,0]
  v_cvt_pk_bf16_f32 v104, v86, v87
  v_pk_mul_f32 v[90:91], v[88:89], v[116:117] op_sel:[0,0] op_sel_hi:[0,1]
  v_pk_fma_f32 v[90:91], v[88:89], v[116:117], v[90:91] op_sel:[1,1,0] op_sel_hi:[1,0,1] neg_lo:[0,1,0]
  v_cvt_pk_bf16_f32 v105, v90, v91
  v_pk_mul_f32 v[94:95], v[92:93], v[116:117] op_sel:[0,0] op_sel_hi:[0,1]
  v_pk_fma_f32 v[94:95], v[92:93], v[116:117], v[94:95] op_sel:[1,1,0] op_sel_hi:[1,0,1] neg_lo:[0,1,0]
  v_cvt_pk_bf16_f32 v106, v94, v95
  v_pk_mul_f32 v[98:99], v[96:97], v[116:117] op_sel:[0,0] op_sel_hi:[0,1]
  v_pk_fma_f32 v[98:99], v[96:97], v[116:117], v[98:99] op_sel:[1,1,0] op_sel_hi:[1,0,1] neg_lo:[0,1,0]
  v_cvt_pk_bf16_f32 v107, v98, v99
  ds_write_addtid_b32 v100 offset:9792
  ds_write_addtid_b32 v101 offset:10080
  ds_write_addtid_b32 v102 offset:10368
  ds_write_addtid_b32 v103 offset:10656
  ds_write_addtid_b32 v104 offset:10944
  ds_write_addtid_b32 v105 offset:11232
  ds_write_addtid_b32 v106 offset:11520
  ds_write_addtid_b32 v107 offset:11808
  ds_read_b128 v[156:159], v210 offset:7488
  ds_read_b128 v[160:163], v210 offset:7552
  ds_read_b128 v[164:167], v210 offset:7616
  ds_read_b128 v[168:171], v210 offset:7680
  s_cmp_ge_u32 s52, 0x03020c0c
  s_mov_b32 s52, 0x03020c0c
  s_cbranch_scc0 KLOOP
  v_readfirstlane_b32 s58, v3
  v_cvt_pk_bf16_f32 v124, v192, v192
  v_cvt_pk_bf16_f32 v125, v192, v192
  v_cvt_pk_bf16_f32 v126, v193, v192
  v_cvt_pk_bf16_f32 v127, v194, v193
  v_cvt_pk_bf16_f32 v128, v194, v194
  v_cvt_pk_bf16_f32 v129, v194, v194
  v_cvt_pk_bf16_f32 v130, v195, v194
  v_cvt_pk_bf16_f32 v131, 0, v195
  v_cvt_pk_bf16_f32 v132, v188, 0
  v_cvt_pk_bf16_f32 v133, v189, v188
  v_cvt_pk_bf16_f32 v134, v190, v189
  v_cvt_pk_bf16_f32 v135, v191, v190
  s_cmp_eq_u32 s58, 0
  s_cbranch_scc1 KTS
KTD:
  s_mov_b32 exec_hi, 1
  ds_write_b128 v212, v[124:127] offset:16
  ds_write_b128 v212, v[128:131] offset:32
  ds_write_b16 v212, v124 offset:12
  s_mov_b32 exec_hi, -1
  ds_write_b128 v213, v[132:135]
  ds_write_b16 v213, v135 offset:18
  s_cmp_eq_u32 s5, 1
  s_waitcnt lgkmcnt(5)
  s_cbranch_scc1 CONV1
  s_branch CONV0
KTS:
  s_mov_b32 s59, 0
SPIN_13:
  ds_read_b32 v3, v1 offset:24
  ds_read_b128 v[212:215], v13 offset:512
  ds_read_b128 v[216:219], v13 offset:1536
  ds_read_b128 v[220:223], v13 offset:2560
  ds_read_b128 v[224:227], v12 offset:12800
  ds_read_b128 v[228:231], v12 offset:13824
  ds_read_b128 v[232:235], v12 offset:14848
  ds_read_b128 v[236:239], v12 offset:15872
  ds_read_b128 v[240:243], v12 offset:16896
  s_add_u32 s59, s59, 1
  s_cmp_gt_u32 s59, 320000
  s_cbranch_scc1 SPD_14
  s_waitcnt lgkmcnt(0)
  v_readfirstlane_b32 s58, v3
  s_cmp_eq_u32 s58, 0
  s_cbranch_scc1 SPIN_13
SPD_14:
  s_waitcnt lgkmcnt(0)
  s_branch KTD
.p2align 12
TC0:
  s_branch RTC
CONV0:
  v_mfma_f32_16x16x32_bf16 v[196:199], v[156:159], v[140:143], v[196:199]
  ds_read2_b32 v[44:45], v216 offset0:230 offset1:228
  ds_read2_b32 v[46:47], v216 offset0:226 offset1:224
  v_mfma_f32_16x16x32_bf16 v[196:199], v[160:163], v[144:147], v[196:199]
  ds_read2_b32 v[76:77], v217 offset0:230 offset1:228
  ds_read2_b32 v[78:79], v217 offset0:226 offset1:224
  v_mfma_f32_16x16x32_bf16 v[196:199], v[164:167], v[148:151], v[196:199]
  ds_read2_b32 v[40:41], v216 offset0:198 offset1:196
  ds_read2_b32 v[42:43], v216 offset0:194 offset1:192
  v_mfma_f32_16x16x32_bf16 v[196:199], v[168:171], v[152:155], v[196:199]
  ds_read2_b32 v[72:73], v217 offset0:198 offset1:196
  ds_read2_b32 v[74:75], v217 offset0:194 offset1:192
  ds_read2_b32 v[36:37], v216 offset0:166 offset1:164
  ds_read2_b32 v[38:39], v216 offset0:162 offset1:160
  ds_read2_b32 v[68:69], v217 offset0:166 offset1:164
  ds_read2_b32 v[70:71], v217 offset0:162 offset1:160
  s_nop 1
  v_cvt_pk_bf16_f32 v8, v196, v197
  v_cvt_pk_bf16_f32 v9, v198, v199
  s_sub_u32 s57, 4, s5
  ds_write_b32 v214, v8
  ds_write_b32 v215, v9
  v_readlane_b32 s49, v9, 31
  ds_read2_b32 v[32:33], v216 offset0:134 offset1:132
  ds_read2_b32 v[34:35], v216 offset0:130 offset1:128
  ds_read2_b32 v[64:65], v217 offset0:134 offset1:132
  ds_read2_b32 v[66:67], v217 offset0:130 offset1:128
  ds_read2_b32 v[28:29], v216 offset0:102 offset1:100
  ds_read2_b32 v[30:31], v216 offset0:98 offset1:96
  ds_read2_b32 v[60:61], v217 offset0:102 offset1:100
  ds_read2_b32 v[62:63], v217 offset0:98 offset1:96
  ds_read2_b32 v[24:25], v216 offset0:70 offset1:68
  ds_read2_b32 v[26:27], v216 offset0:66 offset1:64
  ds_read2_b32 v[56:57], v217 offset0:70 offset1:68
  ds_read2_b32 v[58:59], v217 offset0:66 offset1:64
  ds_read2_b32 v[20:21], v216 offset0:38 offset1:36
  ds_read2_b32 v[22:23], v216 offset0:34 offset1:32
  ds_read2_b32 v[52:53], v217 offset0:38 offset1:36
  ds_read2_b32 v[54:55], v217 offset0:34 offset1:32
  ds_read2_b32 v[16:17], v216 offset0:6 offset1:4
  ds_read2_b32 v[18:19], v216 offset0:2 offset1:0
  ds_read2_b32 v[48:49], v217 offset0:6 offset1:4
  ds_read2_b32 v[50:51], v217 offset0:2 offset1:0
  ds_read2_b32 v[80:81], v218 offset0:6 offset1:4
  ds_read2_b32 v[82:83], v218 offset0:2 offset1:0
  ds_read2_b32 v[116:117], v220 offset0:96 offset1:95
  ds_read2_b32 v[118:119], v220 offset0:94 offset1:93
  s_lshr_b32 s49, s49, 16
  v_mul_u32_u24 v240, s49, v240
  v_mul_u32_u24 v241, s49, v241
  v_mul_u32_u24 v242, s49, v242
  v_mul_u32_u24 v243, s49, v243
  ds_write_b8 v223, v2 offset:28
  s_mov_b32 s59, 0
SPIN_15:
  ds_read_b32 v3, v1 offset:0
  ds_read_b128 v[140:143], v221 offset:32
  ds_read_b128 v[144:147], v221 offset:96
  ds_read_b128 v[148:151], v221 offset:160
  ds_read_b128 v[152:155], v221 offset:224
  s_add_u32 s59, s59, 1
  s_cmp_gt_u32 s59, 320000
  s_cbranch_scc1 SPD_16
  s_waitcnt lgkmcnt(0)
  v_readfirstlane_b32 s58, v3
  s_cmp_lt_u32 s58, s57
  s_cbranch_scc1 SPIN_15
SPD_16:
  s_waitcnt lgkmcnt(0)
  s_setprio 1
  v_mfma_f32_16x16x32_bf16 v[124:127], v[44:47], v[140:143], 0
  ds_read_b128 v[156:159], v221 offset:288
  v_mfma_f32_16x16x32_bf16 v[128:131], v[76:79], v[140:143], 0
  ds_read_b128 v[160:163], v221 offset:352
  v_mfma_f32_16x16x32_bf16 v[124:127], v[40:43], v[144:147], v[124:127]
  ds_read_b128 v[164:167], v221 offset:416
  v_mfma_f32_16x16x32_bf16 v[128:131], v[72:75], v[144:147], v[128:131]
  ds_read_b128 v[168:171], v221 offset:480
  v_mfma_f32_16x16x32_bf16 v[124:127], v[36:39], v[148:151], v[124:127]
  ds_read_b128 v[140:143], v221 offset:544
  v_mfma_f32_16x16x32_bf16 v[128:131], v[68:71], v[148:151], v[128:131]
  ds_read_b128 v[144:147], v221 offset:608
  v_mfma_f32_16x16x32_bf16 v[124:127], v[32:35], v[152:155], v[124:127]
  ds_read_b128 v[148:151], v221 offset:672
  v_mfma_f32_16x16x32_bf16 v[128:131], v[64:67], v[152:155], v[128:131]
  s_waitcnt lgkmcnt(6)
  ds_read2_b32 v[112:113], v220 offset0:80 offset1:79
  v_mfma_f32_16x16x32_bf16 v[124:127], v[28:31], v[156:159], v[124:127]
  ds_read_b128 v[152:155], v221 offset:736
  v_mfma_f32_16x16x32_bf16 v[128:131], v[60:63], v[156:159], v[128:131]
  s_waitcnt lgkmcnt(7)
  ds_read2_b32 v[114:115], v220 offset0:78 offset1:77
  v_mfma_f32_16x16x32_bf16 v[124:127], v[24:27], v[160:163], v[124:127]
  ds_read_b128 v[156:159], v221 offset:800
  v_mfma_f32_16x16x32_bf16 v[128:131], v[56:59], v[160:163], v[128:131]
  s_waitcnt lgkmcnt(8)
  ds_read_b64 v[100:101], v219 offset:512
  v_mfma_f32_16x16x32_bf16 v[124:127], v[20:23], v[164:167], v[124:127]
  s_nop 0
  ds_write_b8 v223, v2 offset:96
  v_mfma_f32_16x16x32_bf16 v[128:131], v[52:55], v[164:167], v[128:131]
  s_waitcnt lgkmcnt(9)
  ds_read_b128 v[160:163], v221 offset:864
  v_mfma_f32_16x16x32_bf16 v[124:127], v[16:19], v[168:171], v[124:127]
  ds_read_b128 v[164:167], v221 offset:928
  v_mfma_f32_16x16x32_bf16 v[128:131], v[48:51], v[168:171], v[128:131]
  s_waitcnt lgkmcnt(10)
  ds_read_b64 v[102:103], v219 offset:504
  v_mfma_f32_16x16x32_bf16 v[128:131], v[44:47], v[140:143], v[128:131]
  s_waitcnt lgkmcnt(10)
  ds_write2st64_b64 v222, v[124:125], v[126:127] offset0:0 offset1:1
  v_mfma_f32_16x16x32_bf16 v[128:131], v[40:43], v[144:147], v[128:131]
  s_waitcnt lgkmcnt(10)
  ds_write_b8 v223, v2 offset:4
  v_mfma_f32_16x16x32_bf16 v[128:131], v[36:39], v[148:151], v[128:131]
  s_waitcnt lgkmcnt(9)
  ds_read_b128 v[168:171], v221 offset:992
  v_mfma_f32_16x16x32_bf16 v[128:131], v[32:35], v[152:155], v[128:131]
  s_waitcnt lgkmcnt(8)
  ds_read_b128 v[140:143], v221 offset:464
  v_mfma_f32_16x16x32_bf16 v[128:131], v[28:31], v[156:159], v[128:131]
  s_waitcnt lgkmcnt(6)
  ds_read_b128 v[144:147], v221 offset:480
  v_mfma_f32_16x16x32_bf16 v[128:131], v[24:27], v[160:163], v[128:131]
  s_waitcnt lgkmcnt(6)
  ds_write_b8 v223, v2 offset:100
  v_mfma_f32_16x16x32_bf16 v[128:131], v[20:23], v[164:167], v[128:131]
  s_waitcnt lgkmcnt(3)
  ds_read_b128 v[148:151], v221 offset:1504
  v_mfma_f32_16x16x32_bf16 v[128:131], v[16:19], v[168:171], v[128:131]
  s_waitcnt lgkmcnt(3)
  ds_read_b128 v[152:155], v221 offset:2528
  v_mfma_f32_16x16x32_bf16 v[176:179], v[140:143], v[236:239], 0
  s_waitcnt lgkmcnt(3)
  ds_read_b128 v[156:159], v221 offset:976
  v_mfma_f32_16x16x32_bf16 v[172:175], v[144:147], v[232:235], 0
  s_waitcnt lgkmcnt(2)
  ds_write2st64_b64 v222, v[128:129], v[130:131] offset0:2 offset1:3
  v_mfma_f32_16x16x32_bf16 v[132:135], v[240:243], v[148:151], 0
  s_waitcnt lgkmcnt(2)
  ds_write_b8 v223, v2 offset:8
  v_mfma_f32_16x16x32_bf16 v[132:135], v[80:83], v[152:155], v[132:135]
  s_waitcnt lgkmcnt(2)
  ds_read_b128 v[160:163], v221 offset:992
  v_cvt_pk_bf16_f32 v188, v172, v176
  v_mfma_f32_16x16x32_bf16 v[184:187], v[156:159], v[236:239], 0
  s_waitcnt lgkmcnt(0)
  ds_read_b128 v[164:167], v221 offset:2592
  v_cvt_pk_bf16_f32 v189, v173, v177
  v_mfma_f32_16x16x32_bf16 v[180:183], v[160:163], v[232:235], 0
  s_waitcnt lgkmcnt(0)
  ds_read_b128 v[168:171], v221 offset:2656
  v_cvt_pk_bf16_f32 v190, v174, v178
  v_mfma_f32_16x16x32_bf16 v[132:135], v[76:79], v[164:167], v[132:135]
  s_waitcnt lgkmcnt(0)
  ds_read_b128 v[140:143], v221 offset:1504
  v_cvt_pk_bf16_f32 v191, v175, v179
  v_mfma_f32_16x16x32_bf16 v[132:135], v[72:75], v[168:171], v[132:135]
  s_waitcnt lgkmcnt(0)
  ds_read_b128 v[144:147], v221 offset:2720
  v_cvt_pk_bf16_f32 v192, v180, v184
  v_mfma_f32_16x16x32_bf16 v[172:175], v[140:143], v[224:227], 0
  ds_read_b128 v[148:151], v221 offset:1488
  v_cvt_pk_bf16_f32 v193, v181, v185
  v_mfma_f32_16x16x32_bf16 v[176:179], v[140:143], v[228:231], 0
  ds_read_b128 v[152:155], v221 offset:2784
  v_cvt_pk_bf16_f32 v194, v182, v186
  v_mfma_f32_16x16x32_bf16 v[132:135], v[188:191], v[116:119], v[132:135]
  s_waitcnt lgkmcnt(2)
  ds_read_b128 v[156:159], v221 offset:1504
  v_cvt_pk_bf16_f32 v195, v183, v187
  v_mfma_f32_16x16x32_bf16 v[132:135], v[68:71], v[144:147], v[132:135]
  s_waitcnt lgkmcnt(2)
  ds_read_b128 v[160:163], v221 offset:2848
  v_cvt_pk_bf16_f32 v196, v172, v176
  v_mfma_f32_16x16x32_bf16 v[180:183], v[148:151], v[224:227], 0
  ds_read_b128 v[164:167], v221 offset:2912
  v_cvt_pk_bf16_f32 v198, v173, v177
  v_mfma_f32_16x16x32_bf16 v[184:187], v[148:151], v[228:231], 0
  ds_read_b128 v[168:171], v221 offset:2016
  v_cvt_pk_bf16_f32 v200, v174, v178
  v_mfma_f32_16x16x32_bf16 v[132:135], v[192:195], v[112:115], v[132:135]
  s_waitcnt lgkmcnt(4)
  ds_read_b64 v[104:105], v219 offset:496
  v_cvt_pk_bf16_f32 v202, v175, v179
  v_mfma_f32_16x16x32_bf16 v[132:135], v[64:67], v[152:155], v[132:135]
  ds_read_b64 v[106:107], v219 offset:488
  v_cvt_pk_bf16_f32 v197, v180, v184
  v_mfma_f32_16x16x32_bf16 v[176:179], v[148:151], v[236:239], 0
  s_waitcnt lgkmcnt(5)
  ds_read_b128 v[140:143], v221 offset:2000
  v_cvt_pk_bf16_f32 v199, v181, v185
  v_mfma_f32_16x16x32_bf16 v[172:175], v[156:159], v[232:235], 0
  s_waitcnt lgkmcnt(5)
  ds_read2_b32 v[108:109], v220 offset0:64 offset1:63
  v_cvt_pk_bf16_f32 v201, v182, v186
  v_mfma_f32_16x16x32_bf16 v[132:135], v[60:63], v[160:163], v[132:135]
  s_waitcnt lgkmcnt(5)
  ds_read2_b32 v[110:111], v220 offset0:62 offset1:61
  v_cvt_pk_bf16_f32 v203, v183, v187
  v_mfma_f32_16x16x32_bf16 v[132:135], v[56:59], v[164:167], v[132:135]
  s_waitcnt lgkmcnt(5)
  ds_read_b128 v[144:147], v221 offset:2976
  v_cvt_pk_bf16_f32 v204, v172, v176
  v_mfma_f32_16x16x32_bf16 v[180:183], v[168:171], v[224:227], 0
  ds_read_b128 v[152:155], v221 offset:2528
  v_cvt_pk_bf16_f32 v205, v173, v177
  v_mfma_f32_16x16x32_bf16 v[184:187], v[168:171], v[228:231], 0
  ds_read_b128 v[148:151], v221 offset:3040
  v_cvt_pk_bf16_f32 v206, v174, v178
  v_mfma_f32_16x16x32_bf16 v[132:135], v[196:199], v[100:103], v[132:135]
  s_waitcnt lgkmcnt(6)
  ds_read_b128 v[156:159], v221 offset:3104
  v_cvt_pk_bf16_f32 v207, v175, v179
  v_mfma_f32_16x16x32_bf16 v[132:135], v[200:203], v[104:107], v[132:135]
  s_waitcnt lgkmcnt(6)
  ds_read_b128 v[160:163], v221 offset:2512
  v_cvt_pk_bf16_f32 v208, v180, v184
  v_mfma_f32_16x16x32_bf16 v[172:175], v[140:143], v[224:227], 0
  ds_read_b64 v[92:93], v219 offset:384
  v_cvt_pk_bf16_f32 v210, v181, v185
  v_mfma_f32_16x16x32_bf16 v[176:179], v[140:143], v[228:231], 0
  s_waitcnt lgkmcnt(6)
  ds_read_b64 v[94:95], v219 offset:376
  v_cvt_pk_bf16_f32 v212, v182, v186
  v_mfma_f32_16x16x32_bf16 v[132:135], v[204:207], v[108:111], v[132:135]
  s_waitcnt lgkmcnt(6)
  ds_read_b64 v[96:97], v219 offset:368
  v_cvt_pk_bf16_f32 v214, v183, v187
  v_mfma_f32_16x16x32_bf16 v[132:135], v[52:55], v[144:147], v[132:135]
  s_waitcnt lgkmcnt(6)
  ds_read_b64 v[98:99], v219 offset:360
  v_cvt_pk_bf16_f32 v209, v172, v176
  v_mfma_f32_16x16x32_bf16 v[180:183], v[152:155], v[224:227], 0
  ds_read_b128 v[164:167], v221 offset:3168
  v_cvt_pk_bf16_f32 v211, v173, v177
  v_mfma_f32_16x16x32_bf16 v[184:187], v[152:155], v[228:231], 0
  s_waitcnt lgkmcnt(7)
  ds_read_b128 v[168:171], v221 offset:3232
  v_cvt_pk_bf16_f32 v213, v174, v178
  v_mfma_f32_16x16x32_bf16 v[132:135], v[48:51], v[148:151], v[132:135]
  s_waitcnt lgkmcnt(7)
  ds_read_b128 v[140:143], v221 offset:3296
  v_cvt_pk_bf16_f32 v215, v175, v179
  v_mfma_f32_16x16x32_bf16 v[132:135], v[44:47], v[156:159], v[132:135]
  s_waitcnt lgkmcnt(7)
  ds_read_b128 v[144:147], v221 offset:3360
  v_cvt_pk_bf16_f32 v244, v180, v184
  v_mfma_f32_16x16x32_bf16 v[172:175], v[160:163], v[224:227], 0
  ds_read_b64 v[84:85], v219 offset:256
  v_cvt_pk_bf16_f32 v246, v181, v185
  v_mfma_f32_16x16x32_bf16 v[176:179], v[160:163], v[228:231], 0
  s_waitcnt lgkmcnt(7)
  ds_read_b64 v[86:87], v219 offset:248
  v_cvt_pk_bf16_f32 v248, v182, v186
  v_mfma_f32_16x16x32_bf16 v[132:135], v[208:211], v[92:95], v[132:135]
  s_waitcnt lgkmcnt(6)
  ds_read_b64 v[88:89], v219 offset:240
  v_cvt_pk_bf16_f32 v250, v183, v187
  v_mfma_f32_16x16x32_bf16 v[132:135], v[212:215], v[96:99], v[132:135]
  s_waitcnt lgkmcnt(6)
  ds_read_b64 v[90:91], v219 offset:232
  v_cvt_pk_bf16_f32 v245, v172, v176
  v_mfma_f32_16x16x32_bf16 v[132:135], v[40:43], v[164:167], v[132:135]
  s_waitcnt lgkmcnt(6)
  ds_read_b128 v[152:155], v221 offset:3424
  v_cvt_pk_bf16_f32 v247, v173, v177
  v_mfma_f32_16x16x32_bf16 v[132:135], v[36:39], v[168:171], v[132:135]
  s_waitcnt lgkmcnt(6)
  ds_read_b128 v[148:151], v221 offset:3488
  v_cvt_pk_bf16_f32 v249, v174, v178
  v_mfma_f32_16x16x32_bf16 v[132:135], v[32:35], v[140:143], v[132:135]
  s_waitcnt lgkmcnt(6)
  ds_read_b128 v[156:159], v221 offset:3552
  v_cvt_pk_bf16_f32 v251, v175, v179
  v_mfma_f32_16x16x32_bf16 v[132:135], v[28:31], v[144:147], v[132:135]
  s_waitcnt lgkmcnt(5)
  ds_read_b128 v[160:163], v221 offset:2000
  v_mfma_f32_16x16x32_bf16 v[132:135], v[244:247], v[84:87], v[132:135]
  s_waitcnt lgkmcnt(4)
  ds_read_b128 v[164:167], v221 offset:2016
  v_mfma_f32_16x16x32_bf16 v[132:135], v[248:251], v[88:91], v[132:135]
  s_waitcnt lgkmcnt(4)
  ds_read2_b32 v[120:121], v220 offset0:112 offset1:111
  v_mfma_f32_16x16x32_bf16 v[132:135], v[24:27], v[152:155], v[132:135]
  s_waitcnt lgkmcnt(4)
  ds_write_b8 v223, v2 offset:104
  v_mfma_f32_16x16x32_bf16 v[132:135], v[20:23], v[148:151], v[132:135]
  s_waitcnt lgkmcnt(4)
  ds_read2_b32 v[122:123], v220 offset0:110 offset1:109
  v_mfma_f32_16x16x32_bf16 v[132:135], v[16:19], v[156:159], v[132:135]
  s_waitcnt lgkmcnt(4)
  ds_read_b128 v[168:171], v221 offset:3040
  v_mfma_f32_16x16x32_bf16 v[184:187], v[160:163], v[236:239], 0
  s_waitcnt lgkmcnt(4)
  ds_read_b128 v[140:143], v221 offset:3024
  v_mfma_f32_16x16x32_bf16 v[180:183], v[164:167], v[232:235], 0
  s_waitcnt lgkmcnt(2)
  ds_write2st64_b64 v222, v[132:133], v[134:135] offset0:4 offset1:5
  v_mfma_f32_16x16x32_bf16 v[136:139], v[188:191], v[120:123], 0
  s_nop 0
  ds_write_b8 v223, v2 offset:12
  v_mfma_f32_16x16x32_bf16 v[136:139], v[192:195], v[116:119], v[136:139]
  s_waitcnt lgkmcnt(3)
  ds_read_b128 v[144:147], v221 offset:2016
  v_cvt_pk_bf16_f32 v252, v180, v184
  v_mfma_f32_16x16x32_bf16 v[172:175], v[168:171], v[224:227], 0
  ds_read_b128 v[152:155], v221 offset:3040
  v_cvt_pk_bf16_f32 v253, v181, v185
  v_mfma_f32_16x16x32_bf16 v[176:179], v[168:171], v[228:231], 0
  ds_read_b128 v[148:151], v221 offset:3104
  v_cvt_pk_bf16_f32 v254, v182, v186
  v_mfma_f32_16x16x32_bf16 v[136:139], v[204:207], v[112:115], v[136:139]
  ds_read_b128 v[156:159], v221 offset:3168
  v_cvt_pk_bf16_f32 v255, v183, v187
  v_mfma_f32_16x16x32_bf16 v[136:139], v[208:211], v[100:103], v[136:139]
  s_waitcnt lgkmcnt(6)
  ds_read_b128 v[160:163], v221 offset:3232
  v_cvt_pk_bf16_f32 v4, v172, v176
  v_mfma_f32_16x16x32_bf16 v[180:183], v[140:143], v[224:227], 0
  ds_read_b128 v[164:167], v221 offset:3296
  v_cvt_pk_bf16_f32 v6, v173, v177
  v_mfma_f32_16x16x32_bf16 v[184:187], v[140:143], v[228:231], 0
  ds_read_b128 v[168:171], v221 offset:3360
  v_cvt_pk_bf16_f32 v8, v174, v178
  v_mfma_f32_16x16x32_bf16 v[136:139], v[212:215], v[104:107], v[136:139]
  ds_read_b128 v[140:143], v221 offset:3424
  v_cvt_pk_bf16_f32 v10, v175, v179
  v_mfma_f32_16x16x32_bf16 v[136:139], v[252:255], v[108:111], v[136:139]
  v_cvt_pk_bf16_f32 v5, v180, v184
  v_mfma_f32_16x16x32_bf16 v[136:139], v[244:247], v[92:95], v[136:139]
  v_cvt_pk_bf16_f32 v7, v181, v185
  v_mfma_f32_16x16x32_bf16 v[136:139], v[248:251], v[96:99], v[136:139]
  s_waitcnt lgkmcnt(7)
  v_cvt_pk_bf16_f32 v9, v182, v186
  v_mfma_f32_16x16x32_bf16 v[136:139], v[240:243], v[144:147], v[136:139]
  s_waitcnt lgkmcnt(6)
  v_cvt_pk_bf16_f32 v11, v183, v187
  v_mfma_f32_16x16x32_bf16 v[136:139], v[80:83], v[152:155], v[136:139]
  ds_read_b128 v[144:147], v221 offset:3488
  v_mfma_f32_16x16x32_bf16 v[136:139], v[4:7], v[84:87], v[136:139]
  ds_read_b128 v[152:155], v221 offset:3552
  v_mfma_f32_16x16x32_bf16 v[136:139], v[8:11], v[88:91], v[136:139]
  s_waitcnt lgkmcnt(7)
  v_mfma_f32_16x16x32_bf16 v[136:139], v[76:79], v[148:151], v[136:139]
  s_waitcnt lgkmcnt(6)
  v_mfma_f32_16x16x32_bf16 v[136:139], v[72:75], v[156:159], v[136:139]
  s_waitcnt lgkmcnt(5)
  ds_read_b128 v[148:151], v221 offset:3616
  v_mfma_f32_16x16x32_bf16 v[136:139], v[68:71], v[160:163], v[136:139]
  s_waitcnt lgkmcnt(5)
  ds_read_b128 v[156:159], v221 offset:3680
  v_mfma_f32_16x16x32_bf16 v[136:139], v[64:67], v[164:167], v[136:139]
  s_waitcnt lgkmcnt(5)
  ds_read_b128 v[160:163], v221 offset:3744
  v_mfma_f32_16x16x32_bf16 v[136:139], v[60:63], v[168:171], v[136:139]
  s_waitcnt lgkmcnt(5)
  ds_read_b128 v[164:167], v221 offset:3808
  v_mfma_f32_16x16x32_bf16 v[136:139], v[56:59], v[140:143], v[136:139]
  s_waitcnt lgkmcnt(5)
  ds_read_b128 v[168:171], v221 offset:3872
  v_mfma_f32_16x16x32_bf16 v[136:139], v[52:55], v[144:147], v[136:139]
  s_waitcnt lgkmcnt(5)
  ds_read_b128 v[140:143], v221 offset:3936
  v_mfma_f32_16x16x32_bf16 v[136:139], v[48:51], v[152:155], v[136:139]
  s_waitcnt lgkmcnt(5)
  ds_read_b128 v[144:147], v221 offset:4000
  v_mfma_f32_16x16x32_bf16 v[136:139], v[44:47], v[148:151], v[136:139]
  s_waitcnt lgkmcnt(5)
  ds_read_b128 v[152:155], v221 offset:4064
  v_mfma_f32_16x16x32_bf16 v[136:139], v[40:43], v[156:159], v[136:139]
  s_waitcnt lgkmcnt(5)
  v_mfma_f32_16x16x32_bf16 v[136:139], v[36:39], v[160:163], v[136:139]
  s_waitcnt lgkmcnt(4)
  v_mfma_f32_16x16x32_bf16 v[136:139], v[32:35], v[164:167], v[136:139]
  s_waitcnt lgkmcnt(3)
  v_mfma_f32_16x16x32_bf16 v[136:139], v[28:31], v[168:171], v[136:139]
  s_waitcnt lgkmcnt(2)
  v_mfma_f32_16x16x32_bf16 v[136:139], v[24:27], v[140:143], v[136:139]
  s_waitcnt lgkmcnt(1)
  ds_write_b8 v223, v2 offset:108
  v_mfma_f32_16x16x32_bf16 v[136:139], v[20:23], v[144:147], v[136:139]
  s_waitcnt lgkmcnt(1)
  v_mfma_f32_16x16x32_bf16 v[136:139], v[16:19], v[152:155], v[136:139]
  s_nop 7
  ds_write2st64_b64 v222, v[136:137], v[138:139] offset0:6 offset1:7
  ds_write_b8 v223, v2 offset:16
  s_endpgm
.p2align 12
TC1:
  s_branch RTC
CONV1:
  v_mfma_f32_16x16x32_bf16 v[196:199], v[156:159], v[140:143], v[196:199]
  ds_read2_b32 v[80:81], v218 offset0:6 offset1:4
  ds_read2_b32 v[82:83], v218 offset0:2 offset1:0
  v_mfma_f32_16x16x32_bf16 v[196:199], v[160:163], v[144:147], v[196:199]
  ds_read2_b32 v[76:77], v217 offset0:230 offset1:228
  ds_read2_b32 v[78:79], v217 offset0:226 offset1:224
  v_mfma_f32_16x16x32_bf16 v[196:199], v[164:167], v[148:151], v[196:199]
  ds_read2_b32 v[72:73], v217 offset0:198 offset1:196
  ds_read2_b32 v[74:75], v217 offset0:194 offset1:192
  v_mfma_f32_16x16x32_bf16 v[196:199], v[168:171], v[152:155], v[196:199]
  ds_read2_b32 v[68:69], v217 offset0:166 offset1:164
  ds_read2_b32 v[70:71], v217 offset0:162 offset1:160
  ds_read2_b32 v[64:65], v217 offset0:134 offset1:132
  ds_read2_b32 v[66:67], v217 offset0:130 offset1:128
  ds_read2_b32 v[60:61], v217 offset0:102 offset1:100
  ds_read2_b32 v[62:63], v217 offset0:98 offset1:96
  s_nop 1
  v_cvt_pk_bf16_f32 v8, v196, v197
  v_cvt_pk_bf16_f32 v9, v198, v199
  s_sub_u32 s57, 4, s5
  ds_write_b32 v214, v8
  ds_write_b32 v215, v9
  v_readlane_b32 s49, v9, 31
  ds_read2_b32 v[56:57], v217 offset0:70 offset1:68
  ds_read2_b32 v[58:59], v217 offset0:66 offset1:64
  ds_read2_b32 v[52:53], v217 offset0:38 offset1:36
  ds_read2_b32 v[54:55], v217 offset0:34 offset1:32
  ds_read2_b32 v[48:49], v217 offset0:6 offset1:4
  ds_read2_b32 v[50:51], v217 offset0:2 offset1:0
  ds_read2_b32 v[44:45], v216 offset0:230 offset1:228
  ds_read2_b32 v[46:47], v216 offset0:226 offset1:224
  ds_read2_b32 v[40:41], v216 offset0:198 offset1:196
  ds_read2_b32 v[42:43], v216 offset0:194 offset1:192
  ds_read2_b32 v[36:37], v216 offset0:166 offset1:164
  ds_read2_b32 v[38:39], v216 offset0:162 offset1:160
  ds_read2_b32 v[32:33], v216 offset0:134 offset1:132
  ds_read2_b32 v[34:35], v216 offset0:130 offset1:128
  ds_read2_b32 v[28:29], v216 offset0:102 offset1:100
  ds_read2_b32 v[30:31], v216 offset0:98 offset1:96
  ds_read2_b32 v[24:25], v216 offset0:70 offset1:68
  ds_read2_b32 v[26:27], v216 offset0:66 offset1:64
  ds_read2_b32 v[20:21], v216 offset0:38 offset1:36
  ds_read2_b32 v[22:23], v216 offset0:34 offset1:32
  ds_read_b64 v[84:85], v219 offset:256
  ds_read_b64 v[86:87], v219 offset:248
  ds_read_b64 v[88:89], v219 offset:240
  ds_read_b64 v[90:91], v219 offset:232
  s_lshr_b32 s49, s49, 16
  v_mul_u32_u24 v240, s49, v240
  v_mul_u32_u24 v241, s49, v241
  v_mul_u32_u24 v242, s49, v242
  v_mul_u32_u24 v243, s49, v243
  ds_write_b8 v223, v2 offset:28
  s_mov_b32 s59, 0
SPIN_17:
  ds_read_b32 v3, v1 offset:0
  ds_read_b128 v[140:143], v221 offset:480
  ds_read_b128 v[144:147], v221 offset:544
  ds_read_b128 v[148:151], v221 offset:464
  ds_read_b128 v[152:155], v221 offset:608
  s_add_u32 s59, s59, 1
  s_cmp_gt_u32 s59, 320000
  s_cbranch_scc1 SPD_18
  s_waitcnt lgkmcnt(0)
  v_readfirstlane_b32 s58, v3
  s_cmp_lt_u32 s58, s57
  s_cbranch_scc1 SPIN_17
SPD_18:
  s_waitcnt lgkmcnt(0)
  s_setprio 1
  v_mfma_f32_16x16x32_bf16 v[172:175], v[140:143], v[224:227], 0
  ds_read_b128 v[156:159], v221 offset:672
  v_mfma_f32_16x16x32_bf16 v[176:179], v[140:143], v[228:231], 0
  ds_read_b128 v[160:163], v221 offset:736
  v_mfma_f32_16x16x32_bf16 v[124:127], v[80:83], v[140:143], 0
  ds_read_b128 v[164:167], v221 offset:800
  v_mfma_f32_16x16x32_bf16 v[124:127], v[76:79], v[144:147], v[124:127]
  ds_read_b128 v[168:171], v221 offset:864
  v_cvt_pk_bf16_f32 v188, v172, v176
  v_mfma_f32_16x16x32_bf16 v[180:183], v[148:151], v[224:227], 0
  ds_read_b128 v[140:143], v221 offset:928
  v_cvt_pk_bf16_f32 v190, v173, v177
  v_mfma_f32_16x16x32_bf16 v[184:187], v[148:151], v[228:231], 0
  ds_read_b128 v[144:147], v221 offset:992
  v_cvt_pk_bf16_f32 v192, v174, v178
  v_mfma_f32_16x16x32_bf16 v[124:127], v[72:75], v[152:155], v[124:127]
  s_waitcnt lgkmcnt(5)
  ds_read_b128 v[148:151], v221 offset:1056
  v_cvt_pk_bf16_f32 v194, v175, v179
  v_mfma_f32_16x16x32_bf16 v[124:127], v[68:71], v[156:159], v[124:127]
  s_waitcnt lgkmcnt(5)
  ds_read_b128 v[152:155], v221 offset:1120
  v_cvt_pk_bf16_f32 v189, v180, v184
  v_mfma_f32_16x16x32_bf16 v[124:127], v[64:67], v[160:163], v[124:127]
  s_waitcnt lgkmcnt(5)
  ds_read_b128 v[156:159], v221 offset:1184
  v_cvt_pk_bf16_f32 v191, v181, v185
  v_mfma_f32_16x16x32_bf16 v[124:127], v[60:63], v[164:167], v[124:127]
  s_waitcnt lgkmcnt(5)
  ds_read_b128 v[160:163], v221 offset:1248
  v_cvt_pk_bf16_f32 v193, v182, v186
  v_mfma_f32_16x16x32_bf16 v[124:127], v[56:59], v[168:171], v[124:127]
  s_waitcnt lgkmcnt(5)
  ds_read_b128 v[164:167], v221 offset:1312
  v_cvt_pk_bf16_f32 v195, v183, v187
  v_mfma_f32_16x16x32_bf16 v[124:127], v[52:55], v[140:143], v[124:127]
  ds_read_b128 v[168:171], v221 offset:1376
  v_mfma_f32_16x16x32_bf16 v[124:127], v[188:191], v[84:87], v[124:127]
  ds_read_b128 v[140:143], v221 offset:1440
  v_mfma_f32_16x16x32_bf16 v[124:127], v[192:195], v[88:91], v[124:127]
  s_waitcnt lgkmcnt(7)
  ds_read2_b32 v[16:17], v216 offset0:6 offset1:4
  v_mfma_f32_16x16x32_bf16 v[124:127], v[48:51], v[144:147], v[124:127]
  s_waitcnt lgkmcnt(7)
  ds_read2_b32 v[18:19], v216 offset0:2 offset1:0
  v_mfma_f32_16x16x32_bf16 v[124:127], v[44:47], v[148:151], v[124:127]
  s_waitcnt lgkmcnt(7)
  ds_read_b128 v[144:147], v221 offset:1504
  v_mfma_f32_16x16x32_bf16 v[124:127], v[40:43], v[152:155], v[124:127]
  s_waitcnt lgkmcnt(7)
  ds_read_b128 v[148:151], v221 offset:992
  v_mfma_f32_16x16x32_bf16 v[124:127], v[36:39], v[156:159], v[124:127]
  s_waitcnt lgkmcnt(7)
  ds_read_b64 v[92:93], v219 offset:384
  v_mfma_f32_16x16x32_bf16 v[124:127], v[32:35], v[160:163], v[124:127]
  s_waitcnt lgkmcnt(7)
  ds_read_b64 v[94:95], v219 offset:376
  v_mfma_f32_16x16x32_bf16 v[124:127], v[28:31], v[164:167], v[124:127]
  s_waitcnt lgkmcnt(7)
  ds_read_b64 v[96:97], v219 offset:368
  v_mfma_f32_16x16x32_bf16 v[124:127], v[24:27], v[168:171], v[124:127]
  s_waitcnt lgkmcnt(7)
  ds_write_b8 v223, v2 offset:96
  v_mfma_f32_16x16x32_bf16 v[124:127], v[20:23], v[140:143], v[124:127]
  s_waitcnt lgkmcnt(5)
  ds_read_b64 v[98:99], v219 offset:360
  v_mfma_f32_16x16x32_bf16 v[124:127], v[16:19], v[144:147], v[124:127]
  s_waitcnt lgkmcnt(5)
  ds_read_b128 v[152:155], v221 offset:976
  v_mfma_f32_16x16x32_bf16 v[172:175], v[148:151], v[224:227], 0
  ds_read_b128 v[156:159], v221 offset:992
  v_mfma_f32_16x16x32_bf16 v[176:179], v[148:151], v[228:231], 0
  s_waitcnt lgkmcnt(5)
  ds_write2st64_b64 v222, v[124:125], v[126:127] offset0:0 offset1:1
  v_mfma_f32_16x16x32_bf16 v[128:131], v[188:191], v[92:95], 0
  s_waitcnt lgkmcnt(3)
  ds_write_b8 v223, v2 offset:4
  v_mfma_f32_16x16x32_bf16 v[128:131], v[192:195], v[96:99], v[128:131]
  s_waitcnt lgkmcnt(3)
  ds_read_b128 v[160:163], v221 offset:1056
  v_cvt_pk_bf16_f32 v196, v172, v176
  v_mfma_f32_16x16x32_bf16 v[180:183], v[152:155], v[224:227], 0
  ds_read_b128 v[164:167], v221 offset:1120
  v_cvt_pk_bf16_f32 v198, v173, v177
  v_mfma_f32_16x16x32_bf16 v[184:187], v[152:155], v[228:231], 0
  s_waitcnt lgkmcnt(4)
  ds_read_b128 v[168:171], v221 offset:1184
  v_cvt_pk_bf16_f32 v200, v174, v178
  v_mfma_f32_16x16x32_bf16 v[128:131], v[80:83], v[156:159], v[128:131]
  s_waitcnt lgkmcnt(2)
  ds_read_b128 v[140:143], v221 offset:1248
  v_cvt_pk_bf16_f32 v202, v175, v179
  v_mfma_f32_16x16x32_bf16 v[128:131], v[76:79], v[160:163], v[128:131]
  s_waitcnt lgkmcnt(2)
  ds_read_b128 v[144:147], v221 offset:1312
  v_cvt_pk_bf16_f32 v197, v180, v184
  v_mfma_f32_16x16x32_bf16 v[128:131], v[72:75], v[164:167], v[128:131]
  s_waitcnt lgkmcnt(2)
  ds_read_b128 v[148:151], v221 offset:1376
  v_cvt_pk_bf16_f32 v199, v181, v185
  v_mfma_f32_16x16x32_bf16 v[128:131], v[68:71], v[168:171], v[128:131]
  s_waitcnt lgkmcnt(2)
  ds_read_b128 v[152:155], v221 offset:1440
  v_cvt_pk_bf16_f32 v201, v182, v186
  v_mfma_f32_16x16x32_bf16 v[128:131], v[64:67], v[140:143], v[128:131]
  s_waitcnt lgkmcnt(2)
  ds_read_b128 v[156:159], v221 offset:1504
  v_cvt_pk_bf16_f32 v203, v183, v187
  v_mfma_f32_16x16x32_bf16 v[128:131], v[60:63], v[144:147], v[128:131]
  ds_read_b128 v[160:163], v221 offset:1568
  v_mfma_f32_16x16x32_bf16 v[128:131], v[196:199], v[84:87], v[128:131]
  ds_read_b128 v[164:167], v221 offset:1632
  v_mfma_f32_16x16x32_bf16 v[128:131], v[200:203], v[88:91], v[128:131]
  s_waitcnt lgkmcnt(4)
  ds_read_b128 v[168:171], v221 offset:1696
  v_mfma_f32_16x16x32_bf16 v[128:131], v[56:59], v[148:151], v[128:131]
  s_waitcnt lgkmcnt(4)
  ds_read_b128 v[140:143], v221 offset:1760
  v_mfma_f32_16x16x32_bf16 v[128:131], v[52:55], v[152:155], v[128:131]
  s_waitcnt lgkmcnt(4)
  ds_read_b128 v[144:147], v221 offset:1824
  v_mfma_f32_16x16x32_bf16 v[128:131], v[48:51], v[156:159], v[128:131]
  s_waitcnt lgkmcnt(4)
  ds_read_b128 v[148:151], v221 offset:1888
  v_mfma_f32_16x16x32_bf16 v[128:131], v[44:47], v[160:163], v[128:131]
  s_waitcnt lgkmcnt(4)
  ds_read_b128 v[152:155], v221 offset:1952
  v_mfma_f32_16x16x32_bf16 v[128:131], v[40:43], v[164:167], v[128:131]
  s_waitcnt lgkmcnt(4)
  ds_read_b128 v[156:159], v221 offset:2016
  v_mfma_f32_16x16x32_bf16 v[128:131], v[36:39], v[168:171], v[128:131]
  s_waitcnt lgkmcnt(4)
  ds_read_b128 v[160:163], v221 offset:464
  v_mfma_f32_16x16x32_bf16 v[128:131], v[32:35], v[140:143], v[128:131]
  s_waitcnt lgkmcnt(4)
  ds_read_b128 v[164:167], v221 offset:480
  v_mfma_f32_16x16x32_bf16 v[128:131], v[28:31], v[144:147], v[128:131]
  s_waitcnt lgkmcnt(4)
  ds_read_b64 v[100:101], v219 offset:512
  v_mfma_f32_16x16x32_bf16 v[128:131], v[24:27], v[148:151], v[128:131]
  s_waitcnt lgkmcnt(4)
  ds_write_b8 v223, v2 offset:100
  v_mfma_f32_16x16x32_bf16 v[128:131], v[20:23], v[152:155], v[128:131]
  s_waitcnt lgkmcnt(4)
  ds_read_b64 v[102:103], v219 offset:504
  v_mfma_f32_16x16x32_bf16 v[128:131], v[16:19], v[156:159], v[128:131]
  s_waitcnt lgkmcnt(4)
  ds_read_b64 v[104:105], v219 offset:496
  v_mfma_f32_16x16x32_bf16 v[176:179], v[160:163], v[236:239], 0
  s_waitcnt lgkmcnt(4)
  ds_read_b64 v[106:107], v219 offset:488
  v_mfma_f32_16x16x32_bf16 v[172:175], v[164:167], v[232:235], 0
  s_waitcnt lgkmcnt(2)
  ds_write2st64_b64 v222, v[128:129], v[130:131] offset0:2 offset1:3
  v_mfma_f32_16x16x32_bf16 v[132:135], v[188:191], v[100:103], 0
  s_waitcnt lgkmcnt(1)
  ds_write_b8 v223, v2 offset:8
  v_mfma_f32_16x16x32_bf16 v[132:135], v[192:195], v[104:107], v[132:135]
  ds_read_b128 v[168:171], v221 offset:1504
  s_waitcnt lgkmcnt(0)
  ds_read_b128 v[140:143], v221 offset:1488
  v_cvt_pk_bf16_f32 v204, v172, v176
  v_mfma_f32_16x16x32_bf16 v[180:183], v[168:171], v[224:227], 0
  ds_read2_b32 v[108:109], v220 offset0:64 offset1:63
  v_cvt_pk_bf16_f32 v205, v173, v177
  v_mfma_f32_16x16x32_bf16 v[184:187], v[168:171], v[228:231], 0
  ds_read2_b32 v[110:111], v220 offset0:62 offset1:61
  v_cvt_pk_bf16_f32 v206, v174, v178
  v_mfma_f32_16x16x32_bf16 v[132:135], v[196:199], v[92:95], v[132:135]
  ds_read_b128 v[144:147], v221 offset:480
  v_cvt_pk_bf16_f32 v207, v175, v179
  v_mfma_f32_16x16x32_bf16 v[132:135], v[200:203], v[96:99], v[132:135]
  s_waitcnt lgkmcnt(3)
  ds_read_b128 v[148:151], v221 offset:1504
  v_cvt_pk_bf16_f32 v208, v180, v184
  v_mfma_f32_16x16x32_bf16 v[172:175], v[140:143], v[224:227], 0
  ds_read_b128 v[152:155], v221 offset:1568
  v_cvt_pk_bf16_f32 v210, v181, v185
  v_mfma_f32_16x16x32_bf16 v[176:179], v[140:143], v[228:231], 0
  s_waitcnt lgkmcnt(3)
  ds_read_b128 v[156:159], v221 offset:1632
  v_cvt_pk_bf16_f32 v212, v182, v186
  v_mfma_f32_16x16x32_bf16 v[132:135], v[204:207], v[108:111], v[132:135]
  s_waitcnt lgkmcnt(3)
  ds_read_b128 v[160:163], v221 offset:1696
  v_cvt_pk_bf16_f32 v214, v183, v187
  v_mfma_f32_16x16x32_bf16 v[132:135], v[240:243], v[144:147], v[132:135]
  s_waitcnt lgkmcnt(3)
  ds_read_b128 v[164:167], v221 offset:1760
  v_cvt_pk_bf16_f32 v209, v172, v176
  v_mfma_f32_16x16x32_bf16 v[132:135], v[80:83], v[148:151], v[132:135]
  s_waitcnt lgkmcnt(3)
  ds_read_b128 v[168:171], v221 offset:1824
  v_cvt_pk_bf16_f32 v211, v173, v177
  v_mfma_f32_16x16x32_bf16 v[132:135], v[76:79], v[152:155], v[132:135]
  s_waitcnt lgkmcnt(3)
  ds_read_b128 v[140:143], v221 offset:1888
  v_cvt_pk_bf16_f32 v213, v174, v178
  v_mfma_f32_16x16x32_bf16 v[132:135], v[72:75], v[156:159], v[132:135]
  s_waitcnt lgkmcnt(3)
  ds_read_b128 v[144:147], v221 offset:1952
  v_cvt_pk_bf16_f32 v215, v175, v179
  v_mfma_f32_16x16x32_bf16 v[132:135], v[68:71], v[160:163], v[132:135]
  ds_read_b128 v[148:151], v221 offset:2016
  v_mfma_f32_16x16x32_bf16 v[132:135], v[208:211], v[84:87], v[132:135]
  ds_read_b128 v[152:155], v221 offset:2080
  v_mfma_f32_16x16x32_bf16 v[132:135], v[212:215], v[88:91], v[132:135]
  s_waitcnt lgkmcnt(5)
  ds_read_b128 v[156:159], v221 offset:2144
  v_mfma_f32_16x16x32_bf16 v[132:135], v[64:67], v[164:167], v[132:135]
  s_waitcnt lgkmcnt(5)
  ds_read_b128 v[160:163], v221 offset:2208
  v_mfma_f32_16x16x32_bf16 v[132:135], v[60:63], v[168:171], v[132:135]
  s_waitcnt lgkmcnt(5)
  ds_read_b128 v[164:167], v221 offset:2272
  v_mfma_f32_16x16x32_bf16 v[132:135], v[56:59], v[140:143], v[132:135]
  s_waitcnt lgkmcnt(5)
  ds_read_b128 v[168:171], v221 offset:2336
  v_mfma_f32_16x16x32_bf16 v[132:135], v[52:55], v[144:147], v[132:135]
  s_waitcnt lgkmcnt(5)
  ds_read_b128 v[140:143], v221 offset:2400
  v_mfma_f32_16x16x32_bf16 v[132:135], v[48:51], v[148:151], v[132:135]
  s_waitcnt lgkmcnt(5)
  ds_read_b128 v[144:147], v221 offset:2464
  v_mfma_f32_16x16x32_bf16 v[132:135], v[44:47], v[152:155], v[132:135]
  s_waitcnt lgkmcnt(5)
  ds_read_b128 v[148:151], v221 offset:2528
  v_mfma_f32_16x16x32_bf16 v[132:135], v[40:43], v[156:159], v[132:135]
  s_waitcnt lgkmcnt(5)
  ds_read_b128 v[152:155], v221 offset:976
  v_mfma_f32_16x16x32_bf16 v[132:135], v[36:39], v[160:163], v[132:135]
  s_waitcnt lgkmcnt(5)
  ds_read_b128 v[156:159], v221 offset:992
  v_mfma_f32_16x16x32_bf16 v[132:135], v[32:35], v[164:167], v[132:135]
  s_waitcnt lgkmcnt(5)
  ds_read2_b32 v[112:113], v220 offset0:80 offset1:79
  v_mfma_f32_16x16x32_bf16 v[132:135], v[28:31], v[168:171], v[132:135]
  s_waitcnt lgkmcnt(5)
  ds_read2_b32 v[114:115], v220 offset0:78 offset1:77
  v_mfma_f32_16x16x32_bf16 v[132:135], v[24:27], v[140:143], v[132:135]
  s_waitcnt lgkmcnt(5)
  ds_write_b8 v223, v2 offset:104
  v_mfma_f32_16x16x32_bf16 v[132:135], v[20:23], v[144:147], v[132:135]
  s_waitcnt lgkmcnt(5)
  ds_read_b128 v[160:163], v221 offset:2016
  v_mfma_f32_16x16x32_bf16 v[132:135], v[16:19], v[148:151], v[132:135]
  s_waitcnt lgkmcnt(5)
  ds_read_b128 v[164:167], v221 offset:2000
  v_mfma_f32_16x16x32_bf16 v[184:187], v[152:155], v[236:239], 0
  s_waitcnt lgkmcnt(5)
  ds_read_b128 v[168:171], v221 offset:992
  v_mfma_f32_16x16x32_bf16 v[180:183], v[156:159], v[232:235], 0
  s_waitcnt lgkmcnt(4)
  ds_write2st64_b64 v222, v[132:133], v[134:135] offset0:4 offset1:5
  v_mfma_f32_16x16x32_bf16 v[136:139], v[204:207], v[112:115], 0
  s_nop 0
  ds_write_b8 v223, v2 offset:12
  v_mfma_f32_16x16x32_bf16 v[136:139], v[196:199], v[100:103], v[136:139]
  s_waitcnt lgkmcnt(4)
  ds_read_b128 v[140:143], v221 offset:2016
  v_cvt_pk_bf16_f32 v244, v180, v184
  v_mfma_f32_16x16x32_bf16 v[172:175], v[160:163], v[224:227], 0
  ds_read_b128 v[144:147], v221 offset:2080
  v_cvt_pk_bf16_f32 v245, v181, v185
  v_mfma_f32_16x16x32_bf16 v[176:179], v[160:163], v[228:231], 0
  ds_read_b128 v[148:151], v221 offset:2144
  v_cvt_pk_bf16_f32 v246, v182, v186
  v_mfma_f32_16x16x32_bf16 v[136:139], v[200:203], v[104:107], v[136:139]
  ds_read_b128 v[152:155], v221 offset:2208
  v_cvt_pk_bf16_f32 v247, v183, v187
  v_mfma_f32_16x16x32_bf16 v[136:139], v[208:211], v[92:95], v[136:139]
  s_waitcnt lgkmcnt(7)
  ds_read_b128 v[156:159], v221 offset:2272
  v_cvt_pk_bf16_f32 v248, v172, v176
  v_mfma_f32_16x16x32_bf16 v[180:183], v[164:167], v[224:227], 0
  ds_read_b128 v[160:163], v221 offset:2336
  v_cvt_pk_bf16_f32 v250, v173, v177
  v_mfma_f32_16x16x32_bf16 v[184:187], v[164:167], v[228:231], 0
  v_cvt_pk_bf16_f32 v252, v174, v178
  v_mfma_f32_16x16x32_bf16 v[136:139], v[244:247], v[108:111], v[136:139]
  ds_read_b128 v[164:167], v221 offset:2400
  v_cvt_pk_bf16_f32 v254, v175, v179
  v_mfma_f32_16x16x32_bf16 v[136:139], v[212:215], v[96:99], v[136:139]
  s_waitcnt lgkmcnt(9)
  v_cvt_pk_bf16_f32 v249, v180, v184
  v_mfma_f32_16x16x32_bf16 v[136:139], v[240:243], v[168:171], v[136:139]
  s_waitcnt lgkmcnt(6)
  v_cvt_pk_bf16_f32 v251, v181, v185
  v_mfma_f32_16x16x32_bf16 v[136:139], v[80:83], v[140:143], v[136:139]
  s_waitcnt lgkmcnt(5)
  ds_read_b128 v[168:171], v221 offset:2464
  v_cvt_pk_bf16_f32 v253, v182, v186
  v_mfma_f32_16x16x32_bf16 v[136:139], v[76:79], v[144:147], v[136:139]
  s_waitcnt lgkmcnt(5)
  ds_read_b128 v[140:143], v221 offset:2528
  v_cvt_pk_bf16_f32 v255, v183, v187
  v_mfma_f32_16x16x32_bf16 v[136:139], v[72:75], v[148:151], v[136:139]
  ds_read_b128 v[144:147], v221 offset:2592
  v_mfma_f32_16x16x32_bf16 v[136:139], v[248:251], v[84:87], v[136:139]
  ds_read_b128 v[148:151], v221 offset:2656
  v_mfma_f32_16x16x32_bf16 v[136:139], v[252:255], v[88:91], v[136:139]
  s_waitcnt lgkmcnt(7)
  v_mfma_f32_16x16x32_bf16 v[136:139], v[68:71], v[152:155], v[136:139]
  s_waitcnt lgkmcnt(6)
  v_mfma_f32_16x16x32_bf16 v[136:139], v[64:67], v[156:159], v[136:139]
  s_waitcnt lgkmcnt(5)
  ds_read_b128 v[152:155], v221 offset:2720
  v_mfma_f32_16x16x32_bf16 v[136:139], v[60:63], v[160:163], v[136:139]
  s_waitcnt lgkmcnt(5)
  ds_read_b128 v[156:159], v221 offset:2784
  v_mfma_f32_16x16x32_bf16 v[136:139], v[56:59], v[164:167], v[136:139]
  s_waitcnt lgkmcnt(5)
  ds_read_b128 v[160:163], v221 offset:2848
  v_mfma_f32_16x16x32_bf16 v[136:139], v[52:55], v[168:171], v[136:139]
  s_waitcnt lgkmcnt(5)
  ds_read_b128 v[164:167], v221 offset:2912
  v_mfma_f32_16x16x32_bf16 v[136:139], v[48:51], v[140:143], v[136:139]
  s_waitcnt lgkmcnt(5)
  ds_read_b128 v[168:171], v221 offset:2976
  v_mfma_f32_16x16x32_bf16 v[136:139], v[44:47], v[144:147], v[136:139]
  s_waitcnt lgkmcnt(5)
  ds_read_b128 v[140:143], v221 offset:3040
  v_mfma_f32_16x16x32_bf16 v[136:139], v[40:43], v[148:151], v[136:139]
  s_waitcnt lgkmcnt(5)
  v_mfma_f32_16x16x32_bf16 v[136:139], v[36:39], v[152:155], v[136:139]
  s_waitcnt lgkmcnt(4)
  v_mfma_f32_16x16x32_bf16 v[136:139], v[32:35], v[156:159], v[136:139]
  s_waitcnt lgkmcnt(3)
  v_mfma_f32_16x16x32_bf16 v[136:139], v[28:31], v[160:163], v[136:139]
  s_waitcnt lgkmcnt(2)
  v_mfma_f32_16x16x32_bf16 v[136:139], v[24:27], v[164:167], v[136:139]
  s_waitcnt lgkmcnt(1)
  ds_write_b8 v223, v2 offset:108
  v_mfma_f32_16x16x32_bf16 v[136:139], v[20:23], v[168:171], v[136:139]
  s_waitcnt lgkmcnt(1)
  v_mfma_f32_16x16x32_bf16 v[136:139], v[16:19], v[140:143], v[136:139]
  s_nop 7
  ds_write2st64_b64 v222, v[136:137], v[138:139] offset0:6 offset1:7
  ds_write_b8 v223, v2 offset:16
  s_endpgm
.p2align 12
SERV:
  s_cmp_gt_u32 s6, 85
  s_cbranch_scc1 SNOF
  s_lshl4_add_u32 s42, s100, 4718592
  v_mov_b32 v16, s42
  v_mov_b32 v18, 0
  v_mov_b32 v19, 0
  s_waitcnt lgkmcnt(0)
  s_add_u32 s101, s101, 35790849
  v_mov_b32 v11, s101
  v_mov_b32 v20, s101
  s_mov_b64 exec, 1
  global_store_dwordx3 v16, v[18:20], s[40:41] sc1
  s_mov_b64 exec, -1
  v_lshrrev_b32 v14, 1, v0
  v_and_b32 v14, 3, v14
  v_and_b32 v9, 24, v0
  v_lshrrev_b32 v15, 5, v0
  v_lshl_add_u32 v14, v15, 2, v14
  v_add_u32 v14, v14, v9
  v_mul_u32_u24 v14, 2752, v14
  v_and_b32 v9, 1, v0
  v_lshl_add_u32 v14, v9, 4, v14
  v_lshl_add_u32 v50, s6, 5, v14
  v_and_b32 v9, 1, v0
  s_lshl_b32 s42, s6, 14
  v_lshrrev_b32 v14, 2, v12
  v_lshl_add_u32 v15, v14, 10, s42
  v_lshl_add_u32 v15, v13, 6, v15
  v_lshl_add_u32 v45, v5, 4, v15
  v_add_u32 v46, 4096, v45
  v_add_u32 v47, 8192, v45
  v_add_u32 v48, 12288, v45
  v_lshlrev_b32 v15, 3, v0
  v_add_u32 v15, 97024, v15
  s_mov_b32 s42, 1056
  v_lshlrev_b32 v14, 6, v14
  v_mad_u32_u24 v14, v13, s42, v14
  v_lshl_add_u32 v14, v5, 3, v14
  v_add_u32 v14, 129792, v14
  v_lshrrev_b32 v8, 1, v12
  v_lshl_add_u32 v8, v8, 2, v13
  v_lshlrev_b32 v8, 4, v8
  v_lshl_add_u32 v9, v9, 11, v8
  s_lshl_b32 s42, s6, 12
  s_add_u32 s42, s42, 4259840
  v_add_u32 v9, s42, v9
  v_lshlrev_b32 v8, 4, v13
  v_bfe_i32 v6, v0, 1, 1
  s_mov_b32 s58, 0x3f803f80
  s_mov_b32 s57, 88064
  s_mov_b32 s59, s58
  s_waitcnt vmcnt(4)
  v_mov_b64 v[192:193], s[58:59]
  v_mov_b64 v[194:195], s[58:59]
  v_mov_b64 v[196:197], s[58:59]
  v_mov_b64 v[198:199], s[58:59]
  v_mov_b64 v[200:201], s[58:59]
  v_mov_b64 v[202:203], s[58:59]
  v_mov_b64 v[204:205], s[58:59]
  v_mov_b64 v[206:207], s[58:59]
  v_mov_b64 v[208:209], s[58:59]
  v_mov_b64 v[210:211], s[58:59]
  v_mov_b64 v[212:213], s[58:59]
  v_mov_b64 v[214:215], s[58:59]
  v_mov_b64 v[216:217], s[58:59]
  v_mov_b64 v[218:219], s[58:59]
  v_mov_b64 v[220:221], s[58:59]
  v_mov_b64 v[222:223], s[58:59]
  v_mov_b64 v[224:225], s[58:59]
  v_mov_b64 v[226:227], s[58:59]
  v_mov_b64 v[228:229], s[58:59]
  v_mov_b64 v[230:231], s[58:59]
  v_mov_b64 v[232:233], s[58:59]
  v_mov_b64 v[234:235], s[58:59]
  v_mov_b64 v[236:237], s[58:59]
  v_mov_b64 v[238:239], s[58:59]
  v_mov_b64 v[240:241], s[58:59]
  v_mov_b64 v[242:243], s[58:59]
  v_mov_b64 v[244:245], s[58:59]
  v_mov_b64 v[246:247], s[58:59]
  v_mov_b64 v[248:249], s[58:59]
  v_mov_b64 v[250:251], s[58:59]
  v_mov_b64 v[252:253], s[58:59]
  v_mov_b64 v[254:255], s[58:59]
  s_mov_b32 m0, 97024
  s_waitcnt vmcnt(4)
  global_load_lds_dwordx4 v50, s[30:31]
  s_addk_i32 m0, 16384
  s_nop 0
  global_load_lds_dwordx4 v50, s[32:33]
  s_addk_i32 m0, -15360
  v_add_u32 v50, s57, v50
  global_load_lds_dwordx4 v50, s[30:31]
  s_addk_i32 m0, 16384
  s_nop 0
  global_load_lds_dwordx4 v50, s[32:33]
  s_addk_i32 m0, -15360
  v_add_u32 v50, s57, v50
  global_load_lds_dwordx4 v50, s[30:31]
  s_addk_i32 m0, 16384
  s_nop 0
  global_load_lds_dwordx4 v50, s[32:33]
  s_addk_i32 m0, -15360
  v_add_u32 v50, s57, v50
  global_load_lds_dwordx4 v50, s[30:31]
  s_addk_i32 m0, 16384
  s_nop 0
  global_load_lds_dwordx4 v50, s[32:33]
  s_addk_i32 m0, -15360
  v_add_u32 v50, s57, v50
  global_load_lds_dwordx4 v50, s[30:31]
  s_addk_i32 m0, 16384
  s_nop 0
  global_load_lds_dwordx4 v50, s[32:33]
  s_addk_i32 m0, -15360
  v_add_u32 v50, s57, v50
  global_load_lds_dwordx4 v50, s[30:31]
  s_addk_i32 m0, 16384
  s_nop 0
  global_load_lds_dwordx4 v50, s[32:33]
  s_addk_i32 m0, -15360
  v_add_u32 v50, s57, v50
  global_load_lds_dwordx4 v50, s[30:31]
  s_addk_i32 m0, 16384
  s_nop 0
  global_load_lds_dwordx4 v50, s[32:33]
  s_addk_i32 m0, -15360
  v_add_u32 v50, s57, v50
  global_load_lds_dwordx4 v50, s[30:31]
  s_addk_i32 m0, 16384
  s_nop 0
  global_load_lds_dwordx4 v50, s[32:33]
  s_addk_i32 m0, -15360
  v_add_u32 v50, s57, v50
  global_load_lds_dwordx4 v50, s[30:31]
  s_addk_i32 m0, 16384
  s_nop 0
  global_load_lds_dwordx4 v50, s[32:33]
  s_addk_i32 m0, -15360
  v_add_u32 v50, s57, v50
  global_load_lds_dwordx4 v50, s[30:31]
  s_addk_i32 m0, 16384
  s_nop 0
  global_load_lds_dwordx4 v50, s[32:33]
  s_addk_i32 m0, -15360
  v_add_u32 v50, s57, v50
  global_load_lds_dwordx4 v50, s[30:31]
  s_addk_i32 m0, 16384
  s_nop 0
  global_load_lds_dwordx4 v50, s[32:33]
  s_addk_i32 m0, -15360
  v_add_u32 v50, s57, v50
  global_load_lds_dwordx4 v50, s[30:31]
  s_addk_i32 m0, 16384
  s_nop 0
  global_load_lds_dwordx4 v50, s[32:33]
  s_addk_i32 m0, -15360
  v_add_u32 v50, s57, v50
  global_load_lds_dwordx4 v50, s[30:31]
  s_addk_i32 m0, 16384
  s_nop 0
  global_load_lds_dwordx4 v50, s[32:33]
  s_addk_i32 m0, -15360
  v_add_u32 v50, s57, v50
  global_load_lds_dwordx4 v50, s[30:31]
  s_addk_i32 m0, 16384
  s_nop 0
  global_load_lds_dwordx4 v50, s[32:33]
  s_addk_i32 m0, -15360
  v_add_u32 v50, s57, v50
  global_load_lds_dwordx4 v50, s[30:31]
  s_addk_i32 m0, 16384
  s_nop 0
  global_load_lds_dwordx4 v50, s[32:33]
  s_addk_i32 m0, -15360
  v_add_u32 v50, s57, v50
  global_load_lds_dwordx4 v50, s[30:31]
  s_addk_i32 m0, 16384
  s_nop 0
  global_load_lds_dwordx4 v50, s[32:33]
  s_waitcnt vmcnt(30)
  s_addk_i32 m0, 1024
  s_nop 0
  global_load_lds_dwordx4 v45, s[34:35] offset:0
  s_addk_i32 m0, 1056
  s_nop 0
  global_load_lds_dwordx4 v46, s[34:35] offset:0
  ds_read_b64_tr_b16 v[64:65], v15 offset:0
  ds_read_b64_tr_b16 v[66:67], v15 offset:512
  ds_read_b64_tr_b16 v[68:69], v15 offset:16384
  ds_read_b64_tr_b16 v[70:71], v15 offset:16896
  s_waitcnt vmcnt(30)
  s_addk_i32 m0, 1056
  s_nop 0
  global_load_lds_dwordx4 v47, s[34:35] offset:0
  s_addk_i32 m0, 1056
  s_nop 0
  global_load_lds_dwordx4 v48, s[34:35] offset:0
  ds_read_b64_tr_b16 v[72:73], v15 offset:1024
  ds_read_b64_tr_b16 v[74:75], v15 offset:1536
  ds_read_b64_tr_b16 v[76:77], v15 offset:17408
  ds_read_b64_tr_b16 v[78:79], v15 offset:17920
  s_waitcnt vmcnt(30)
  s_addk_i32 m0, 800
  s_nop 0
  global_load_lds_dwordx4 v45, s[34:35] offset:256
  s_addk_i32 m0, 1056
  s_nop 0
  global_load_lds_dwordx4 v46, s[34:35] offset:256
  ds_read_b64_tr_b16 v[80:81], v15 offset:2048
  ds_read_b64_tr_b16 v[82:83], v15 offset:2560
  ds_read_b64_tr_b16 v[84:85], v15 offset:18432
  ds_read_b64_tr_b16 v[86:87], v15 offset:18944
  s_waitcnt vmcnt(30)
  s_addk_i32 m0, 1056
  s_nop 0
  global_load_lds_dwordx4 v47, s[34:35] offset:256
  s_addk_i32 m0, 1056
  s_nop 0
  global_load_lds_dwordx4 v48, s[34:35] offset:256
  ds_read_b64_tr_b16 v[88:89], v15 offset:3072
  ds_read_b64_tr_b16 v[90:91], v15 offset:3584
  ds_read_b64_tr_b16 v[92:93], v15 offset:19456
  ds_read_b64_tr_b16 v[94:95], v15 offset:19968
  s_waitcnt vmcnt(30)
  s_addk_i32 m0, 800
  s_nop 0
  global_load_lds_dwordx4 v45, s[34:35] offset:512
  s_addk_i32 m0, 1056
  s_nop 0
  global_load_lds_dwordx4 v46, s[34:35] offset:512
  ds_read_b64_tr_b16 v[96:97], v15 offset:4096
  ds_read_b64_tr_b16 v[98:99], v15 offset:4608
  ds_read_b64_tr_b16 v[100:101], v15 offset:20480
  ds_read_b64_tr_b16 v[102:103], v15 offset:20992
  s_waitcnt vmcnt(30)
  s_addk_i32 m0, 1056
  s_nop 0
  global_load_lds_dwordx4 v47, s[34:35] offset:512
  s_addk_i32 m0, 1056
  s_nop 0
  global_load_lds_dwordx4 v48, s[34:35] offset:512
  ds_read_b64_tr_b16 v[104:105], v15 offset:5120
  ds_read_b64_tr_b16 v[106:107], v15 offset:5632
  ds_read_b64_tr_b16 v[108:109], v15 offset:21504
  ds_read_b64_tr_b16 v[110:111], v15 offset:22016
  s_waitcnt vmcnt(30)
  s_addk_i32 m0, 800
  s_nop 0
  global_load_lds_dwordx4 v45, s[34:35] offset:768
  s_addk_i32 m0, 1056
  s_nop 0
  global_load_lds_dwordx4 v46, s[34:35] offset:768
  ds_read_b64_tr_b16 v[112:113], v15 offset:6144
  ds_read_b64_tr_b16 v[114:115], v15 offset:6656
  ds_read_b64_tr_b16 v[116:117], v15 offset:22528
  ds_read_b64_tr_b16 v[118:119], v15 offset:23040
  s_waitcnt vmcnt(30)
  s_addk_i32 m0, 1056
  s_nop 0
  global_load_lds_dwordx4 v47, s[34:35] offset:768
  s_addk_i32 m0, 1056
  s_nop 0
  global_load_lds_dwordx4 v48, s[34:35] offset:768
  ds_read_b64_tr_b16 v[120:121], v15 offset:7168
  ds_read_b64_tr_b16 v[122:123], v15 offset:7680
  ds_read_b64_tr_b16 v[124:125], v15 offset:23552
  ds_read_b64_tr_b16 v[126:127], v15 offset:24064
  s_waitcnt vmcnt(30)
  ds_read_b64_tr_b16 v[128:129], v15 offset:8192
  ds_read_b64_tr_b16 v[130:131], v15 offset:8704
  ds_read_b64_tr_b16 v[132:133], v15 offset:24576
  ds_read_b64_tr_b16 v[134:135], v15 offset:25088
  s_waitcnt vmcnt(28)
  ds_read_b64_tr_b16 v[136:137], v15 offset:9216
  ds_read_b64_tr_b16 v[138:139], v15 offset:9728
  ds_read_b64_tr_b16 v[140:141], v15 offset:25600
  ds_read_b64_tr_b16 v[142:143], v15 offset:26112
  s_waitcnt vmcnt(26)
  ds_write_b64 v1, v[10:11] offset:64
  ds_read_b64_tr_b16 v[144:145], v15 offset:10240
  ds_read_b64_tr_b16 v[146:147], v15 offset:10752
  ds_read_b64_tr_b16 v[148:149], v15 offset:26624
  ds_read_b64_tr_b16 v[150:151], v15 offset:27136
  s_waitcnt vmcnt(24)
  ds_read_b64_tr_b16 v[152:153], v15 offset:11264
  ds_read_b64_tr_b16 v[154:155], v15 offset:11776
  ds_read_b64_tr_b16 v[156:157], v15 offset:27648
  ds_read_b64_tr_b16 v[158:159], v15 offset:28160
  s_waitcnt vmcnt(22)
  global_load_dwordx3 v[24:26], v52, s[40:41] offset:0 sc1
  global_load_dwordx3 v[28:30], v52, s[40:41] offset:1024 sc1
  global_load_dwordx3 v[32:34], v52, s[40:41] offset:2048 sc1
  ds_read_b64_tr_b16 v[160:161], v15 offset:12288
  ds_read_b64_tr_b16 v[162:163], v15 offset:12800
  ds_read_b64_tr_b16 v[164:165], v15 offset:28672
  ds_read_b64_tr_b16 v[166:167], v15 offset:29184
  s_waitcnt vmcnt(23)
  ds_read_b64_tr_b16 v[168:169], v15 offset:13312
  ds_read_b64_tr_b16 v[170:171], v15 offset:13824
  ds_read_b64_tr_b16 v[172:173], v15 offset:29696
  ds_read_b64_tr_b16 v[174:175], v15 offset:30208
  s_waitcnt vmcnt(21)
  ds_read_b64_tr_b16 v[176:177], v15 offset:14336
  ds_read_b64_tr_b16 v[178:179], v15 offset:14848
  ds_read_b64_tr_b16 v[180:181], v15 offset:30720
  ds_read_b64_tr_b16 v[182:183], v15 offset:31232
  s_waitcnt vmcnt(19)
  ds_read_b64_tr_b16 v[184:185], v15 offset:15360
  ds_read_b64_tr_b16 v[186:187], v15 offset:15872
  ds_read_b64_tr_b16 v[188:189], v15 offset:31744
  ds_read_b64_tr_b16 v[190:191], v15 offset:32256
KP0:
  s_mov_b32 s48, 0
KPW:
  s_waitcnt vmcnt(0)
KPX:
  v_min3_u32 v16, v26, v30, v11
  v_max3_u32 v17, v26, v30, v11
  v_min3_u32 v16, v16, v34, v34
  v_max3_u32 v17, v17, v34, v34
  s_add_u32 s48, s48, 1
  v_cmp_ne_u32 vcc, v16, v17
  s_cmp_gt_u32 s48, 20000
  s_cbranch_vccz KDONE
  s_cbranch_scc1 KDONE
  s_mov_b64 exec, vcc
  global_load_dwordx3 v[24:26], v52, s[40:41] offset:0 sc1
  global_load_dwordx3 v[28:30], v52, s[40:41] offset:1024 sc1
  global_load_dwordx3 v[32:34], v52, s[40:41] offset:2048 sc1
  s_branch KPW
SNOF:
  s_setprio 0
  s_mov_b32 s59, 0
SPIN_19:
  ds_read_b32 v3, v1 offset:64
  ds_read_b32 v11, v1 offset:68
  s_add_u32 s59, s59, 1
  s_cmp_gt_u32 s59, 320000
  s_cbranch_scc1 SPD_20
  s_waitcnt lgkmcnt(0)
  v_readfirstlane_b32 s58, v3
  s_cmp_eq_u32 s58, 0
  s_cbranch_scc1 SPIN_19
SPD_20:
  s_waitcnt lgkmcnt(0)
  s_mov_b32 s59, 0
SPIN_21:
  ds_read_b32 v3, v1 offset:0
  s_add_u32 s59, s59, 1
  s_cmp_gt_u32 s59, 320000
  s_cbranch_scc1 SPD_22
  s_waitcnt lgkmcnt(0)
  v_readfirstlane_b32 s58, v3
  s_cmp_lt_u32 s58, 1
  s_cbranch_scc1 SPIN_21
SPD_22:
  s_waitcnt lgkmcnt(0)
  global_load_dwordx3 v[24:26], v52, s[40:41] offset:0 sc1
  global_load_dwordx3 v[28:30], v52, s[40:41] offset:1024 sc1
  global_load_dwordx3 v[32:34], v52, s[40:41] offset:2048 sc1
  s_branch KP0
KDONE:
  s_mov_b64 exec, -1
  v_min_u32 v20, v24, v28
  v_max_u32 v16, v24, v28
  v_max3_u32 v17, v25, v29, v20
  v_min_u32 v20, v16, v32
  v_max_u32 v16, v16, v32
  v_max3_u32 v17, v17, v33, v20
  s_nop 0
  v_min_u32_dpp v20, v16, v16 quad_perm:[1,0,3,2] row_mask:0xf bank_mask:0xf
  v_max_u32_dpp v16, v16, v16 quad_perm:[1,0,3,2] row_mask:0xf bank_mask:0xf
  v_max_u32_dpp v17, v17, v17 quad_perm:[1,0,3,2] row_mask:0xf bank_mask:0xf
  v_max_u32 v17, v17, v20
  v_min_u32_dpp v20, v16, v16 quad_perm:[2,3,0,1] row_mask:0xf bank_mask:0xf
  v_max_u32_dpp v16, v16, v16 quad_perm:[2,3,0,1] row_mask:0xf bank_mask:0xf
  v_max_u32_dpp v17, v17, v17 quad_perm:[2,3,0,1] row_mask:0xf bank_mask:0xf
  v_max_u32 v17, v17, v20
  v_min_u32_dpp v20, v16, v16 row_half_mirror row_mask:0xf bank_mask:0xf
  v_max_u32_dpp v16, v16, v16 row_half_mirror row_mask:0xf bank_mask:0xf
  v_max_u32_dpp v17, v17, v17 row_half_mirror row_mask:0xf bank_mask:0xf
  v_max_u32 v17, v17, v20
  v_min_u32_dpp v20, v16, v16 row_mirror row_mask:0xf bank_mask:0xf
  v_max_u32_dpp v16, v16, v16 row_mirror row_mask:0xf bank_mask:0xf
  v_max_u32_dpp v17, v17, v17 row_mirror row_mask:0xf bank_mask:0xf
  v_max_u32 v17, v17, v20
  v_min_u32_dpp v20, v16, v16 row_bcast:15 row_mask:0xa bank_mask:0xf
  v_max_u32_dpp v16, v16, v16 row_bcast:15 row_mask:0xa bank_mask:0xf
  v_max_u32_dpp v17, v17, v17 row_bcast:15 row_mask:0xa bank_mask:0xf
  v_max_u32 v17, v17, v20
  v_min_u32_dpp v20, v16, v16 row_bcast:31 row_mask:0xc bank_mask:0xf
  v_max_u32_dpp v16, v16, v16 row_bcast:31 row_mask:0xc bank_mask:0xf
  v_max_u32_dpp v17, v17, v17 row_bcast:31 row_mask:0xc bank_mask:0xf
  v_max_u32 v17, v17, v20
  v_readlane_b32 s96, v16, 63
  s_mov_b32 vcc_lo, 0xaaaaaaaa
  v_readlane_b32 s97, v17, 63
  s_mov_b32 vcc_hi, 0xaaaaaaaa
  v_mov_b32 v16, s96
  s_or_b32 s97, s97, 0x8000
  v_mov_b32 v17, s97
  v_cndmask_b32 v16, v16, v17, vcc
  v_and_b32 v17, 0x7ff, v16
  s_cmp_gt_u32 s6, 85
  s_cbranch_scc1 KNX
  v_lshl_add_u32 v8, v17, 10, v8
  s_mov_b32 exec_lo, 0x00030003
  s_mov_b32 exec_hi, 0x00030003
  global_load_dwordx4 v[192:195], v8, s[8:9] offset:0
  global_load_dwordx4 v[196:199], v8, s[8:9] offset:64
  global_load_dwordx4 v[200:203], v8, s[8:9] offset:128
  global_load_dwordx4 v[204:207], v8, s[8:9] offset:192
  global_load_dwordx4 v[208:211], v8, s[8:9] offset:256
  global_load_dwordx4 v[212:215], v8, s[8:9] offset:320
  global_load_dwordx4 v[216:219], v8, s[8:9] offset:384
  global_load_dwordx4 v[220:223], v8, s[8:9] offset:448
  global_load_dwordx4 v[224:227], v8, s[8:9] offset:512
  global_load_dwordx4 v[228:231], v8, s[8:9] offset:576
  global_load_dwordx4 v[232:235], v8, s[8:9] offset:640
  global_load_dwordx4 v[236:239], v8, s[8:9] offset:704
  global_load_dwordx4 v[240:243], v8, s[8:9] offset:768
  global_load_dwordx4 v[244:247], v8, s[8:9] offset:832
  global_load_dwordx4 v[248:251], v8, s[8:9] offset:896
  global_load_dwordx4 v[252:255], v8, s[8:9] offset:960
  s_mov_b64 exec, -1
KNX:
  ds_write_b64 v23, v[16:17] offset:32
  s_cbranch_scc0 FFN
  s_branch FINS
STR:
  global_load_dwordx2 v[20:21], v44, s[40:41] sc1
  s_add_u32 s48, s48, 1
  s_cmp_gt_u32 s48, 20000
  s_cbranch_scc0 STC
  s_waitcnt vmcnt(0)
  s_branch STD
FFN:
  v_and_b32 v44, 0x701, v16
  v_and_b32 v19, 14, v16
  v_lshl_add_u32 v44, v19, 4, v44
  v_and_b32 v19, 0xf0, v16
  v_lshl_add_u32 v44, v44, 3, v19
  v_add_u32 v44, 4784128, v44
  global_load_dwordx2 v[20:21], v44, s[40:41] sc1
  s_mov_b32 s96, 0x7060500
  s_mov_b32 s97, 0x7060501
  s_mov_b32 s98, 0x7060502
  s_mov_b32 s99, 0x7060503
  s_waitcnt lgkmcnt(0)
  s_waitcnt vmcnt(16)
  v_mfma_f32_16x16x32_bf16 v[56:59], v[64:67], v[192:195], 0
  v_mfma_f32_16x16x32_bf16 v[60:63], v[68:71], v[192:195], 0
  s_waitcnt vmcnt(15)
  v_mfma_f32_16x16x32_bf16 v[56:59], v[72:75], v[196:199], v[56:59]
  s_nop 0
  ds_read_b64_tr_b16 v[64:65], v14 offset:0
  ds_read_b64_tr_b16 v[66:67], v14 offset:32
  v_mfma_f32_16x16x32_bf16 v[60:63], v[76:79], v[196:199], v[60:63]
  s_nop 0
  ds_read_b64_tr_b16 v[68:69], v14 offset:4224
  ds_read_b64_tr_b16 v[70:71], v14 offset:4256
  s_waitcnt vmcnt(14)
  v_mfma_f32_16x16x32_bf16 v[56:59], v[80:83], v[200:203], v[56:59]
  s_nop 0
  ds_read_b64_tr_b16 v[72:73], v14 offset:8448
  ds_read_b64_tr_b16 v[74:75], v14 offset:8480
  v_mfma_f32_16x16x32_bf16 v[60:63], v[84:87], v[200:203], v[60:63]
  s_nop 0
  ds_read_b64_tr_b16 v[76:77], v14 offset:12672
  ds_read_b64_tr_b16 v[78:79], v14 offset:12704
  s_waitcnt vmcnt(13)
  v_mfma_f32_16x16x32_bf16 v[56:59], v[88:91], v[204:207], v[56:59]
  s_nop 0
  ds_read_b64_tr_b16 v[80:81], v14 offset:256
  ds_read_b64_tr_b16 v[82:83], v14 offset:288
  v_mfma_f32_16x16x32_bf16 v[60:63], v[92:95], v[204:207], v[60:63]
  s_nop 0
  ds_read_b64_tr_b16 v[84:85], v14 offset:4480
  ds_read_b64_tr_b16 v[86:87], v14 offset:4512
  s_waitcnt vmcnt(12)
  v_mfma_f32_16x16x32_bf16 v[56:59], v[96:99], v[208:211], v[56:59]
  s_nop 0
  ds_read_b64_tr_b16 v[88:89], v14 offset:8704
  ds_read_b64_tr_b16 v[90:91], v14 offset:8736
  v_mfma_f32_16x16x32_bf16 v[60:63], v[100:103], v[208:211], v[60:63]
  s_nop 0
  ds_read_b64_tr_b16 v[92:93], v14 offset:12928
  ds_read_b64_tr_b16 v[94:95], v14 offset:12960
  s_waitcnt vmcnt(11)
  v_mfma_f32_16x16x32_bf16 v[56:59], v[104:107], v[212:215], v[56:59]
  s_nop 0
  ds_read_b64_tr_b16 v[96:97], v14 offset:512
  ds_read_b64_tr_b16 v[98:99], v14 offset:544
  v_mfma_f32_16x16x32_bf16 v[60:63], v[108:111], v[212:215], v[60:63]
  s_nop 0
  ds_read_b64_tr_b16 v[100:101], v14 offset:4736
  ds_read_b64_tr_b16 v[102:103], v14 offset:4768
  s_waitcnt vmcnt(10)
  v_mfma_f32_16x16x32_bf16 v[56:59], v[112:115], v[216:219], v[56:59]
  s_nop 0
  ds_read_b64_tr_b16 v[104:105], v14 offset:8960
  ds_read_b64_tr_b16 v[106:107], v14 offset:8992
  v_mfma_f32_16x16x32_bf16 v[60:63], v[116:119], v[216:219], v[60:63]
  s_nop 0
  ds_read_b64_tr_b16 v[108:109], v14 offset:13184
  ds_read_b64_tr_b16 v[110:111], v14 offset:13216
  s_waitcnt vmcnt(9)
  v_mfma_f32_16x16x32_bf16 v[56:59], v[120:123], v[220:223], v[56:59]
  s_nop 0
  ds_read_b64_tr_b16 v[112:113], v14 offset:768
  ds_read_b64_tr_b16 v[114:115], v14 offset:800
  v_mfma_f32_16x16x32_bf16 v[60:63], v[124:127], v[220:223], v[60:63]
  s_nop 0
  ds_read_b64_tr_b16 v[116:117], v14 offset:4992
  ds_read_b64_tr_b16 v[118:119], v14 offset:5024
  s_waitcnt vmcnt(8)
  v_mfma_f32_16x16x32_bf16 v[56:59], v[128:131], v[224:227], v[56:59]
  s_nop 0
  ds_read_b64_tr_b16 v[120:121], v14 offset:9216
  ds_read_b64_tr_b16 v[122:123], v14 offset:9248
  v_mfma_f32_16x16x32_bf16 v[60:63], v[132:135], v[224:227], v[60:63]
  s_nop 0
  ds_read_b64_tr_b16 v[124:125], v14 offset:13440
  ds_read_b64_tr_b16 v[126:127], v14 offset:13472
  s_waitcnt vmcnt(7)
  v_mfma_f32_16x16x32_bf16 v[56:59], v[136:139], v[228:231], v[56:59]
  v_mov_b32 v24, 0
  v_mov_b32 v25, 0
  v_mfma_f32_16x16x32_bf16 v[60:63], v[140:143], v[228:231], v[60:63]
  v_mov_b32 v26, 0
  v_mov_b32 v27, 0
  s_waitcnt vmcnt(6)
  v_mfma_f32_16x16x32_bf16 v[56:59], v[144:147], v[232:235], v[56:59]
  v_mov_b32 v28, 0
  v_mov_b32 v29, 0
  v_mfma_f32_16x16x32_bf16 v[60:63], v[148:151], v[232:235], v[60:63]
  v_mov_b32 v30, 0
  v_mov_b32 v31, 0
  s_waitcnt vmcnt(5)
  v_mfma_f32_16x16x32_bf16 v[56:59], v[152:155], v[236:239], v[56:59]
  v_mov_b32 v32, 0
  v_mov_b32 v33, 0
  v_mfma_f32_16x16x32_bf16 v[60:63], v[156:159], v[236:239], v[60:63]
  v_mov_b32 v34, 0
  v_mov_b32 v35, 0
  s_waitcnt vmcnt(4)
  v_mfma_f32_16x16x32_bf16 v[56:59], v[160:163], v[240:243], v[56:59]
  v_mov_b32 v36, 0
  v_mov_b32 v37, 0
  v_mfma_f32_16x16x32_bf16 v[60:63], v[164:167], v[240:243], v[60:63]
  v_mov_b32 v38, 0
  v_mov_b32 v39, 0
  s_waitcnt vmcnt(3)
  v_mfma_f32_16x16x32_bf16 v[56:59], v[168:171], v[244:247], v[56:59]
  v_mfma_f32_16x16x32_bf16 v[60:63], v[172:175], v[244:247], v[60:63]
  s_waitcnt vmcnt(2)
  v_mfma_f32_16x16x32_bf16 v[56:59], v[176:179], v[248:251], v[56:59]
  v_mfma_f32_16x16x32_bf16 v[60:63], v[180:183], v[248:251], v[60:63]
  s_waitcnt vmcnt(1)
  v_mfma_f32_16x16x32_bf16 v[56:59], v[184:187], v[252:255], v[56:59]
  v_mfma_f32_16x16x32_bf16 v[60:63], v[188:191], v[252:255], v[60:63]
STC:
  s_waitcnt vmcnt(0)
  v_cmp_ne_u32 vcc, v21, v11
  v_and_b32 v21, s56, v20
  s_cbranch_vccnz STR
STD:
  v_rcp_f32 v21, v21
  v_lshlrev_b32 v20, 16, v20
  v_mov_b32_dpp v56, v57 row_shr:4 row_mask:0xf bank_mask:0x2
  s_nop 0
  v_mov_b32_dpp v60, v61 row_shr:4 row_mask:0xf bank_mask:0x2
  v_mov_b32_dpp v56, v58 row_shr:8 row_mask:0xf bank_mask:0x4
  s_nop 0
  v_mov_b32_dpp v60, v62 row_shr:8 row_mask:0xf bank_mask:0x4
  v_mov_b32_dpp v56, v59 row_shr:12 row_mask:0xf bank_mask:0x8
  s_nop 0
  v_mov_b32_dpp v60, v63 row_shr:12 row_mask:0xf bank_mask:0x8
  v_mul_f32 v22, 0xbfb8aa3b, v21
  v_fmac_f32_dpp v56, -v56, v20 quad_perm:[2,3,2,3] row_mask:0xf bank_mask:0xf
  v_fmac_f32_dpp v60, -v60, v20 quad_perm:[2,3,2,3] row_mask:0xf bank_mask:0xf
  v_mul_f32 v22, v22, v56
  v_exp_f32 v22, v22
  v_mul_f32 v21, v21, v21
  v_mul_f32 v56, v56, v60
  v_add_f32 v22, 1.0, v22
  v_rcp_f32 v22, v22
  v_bfi_b32 v21, v6, 0, v21
  v_mul_f32 v56, v56, v21
  v_mul_f32 v56, v56, v22
  s_waitcnt lgkmcnt(0)
  s_nop 0
  v_mov_b32_dpp v22, v56 row_shl:4 row_mask:0xf bank_mask:0xf bound_ctrl:0
  v_cvt_pk_bf16_f32 v22, v56, v22
  s_nop 1
  v_mov_b32_dpp v24, v22 quad_perm:[0,1,2,3] row_mask:0xf bank_mask:0x1
  v_mov_b32_dpp v25, v22 row_shl:8 row_mask:0xf bank_mask:0x1
  v_mov_b32_dpp v26, v22 row_shr:2 row_mask:0xf bank_mask:0x1
  v_mov_b32_dpp v27, v22 row_shl:6 row_mask:0xf bank_mask:0x1
  v_mov_b32_dpp v28, v22 row_shr:4 row_mask:0xf bank_mask:0x2
  v_mov_b32_dpp v29, v22 row_shl:4 row_mask:0xf bank_mask:0x2
  v_mfma_f32_16x16x32_bf16 v[192:195], v[64:67], v[24:27], 0
  v_mov_b32_dpp v30, v22 row_shr:6 row_mask:0xf bank_mask:0x2
  v_mov_b32_dpp v31, v22 row_shl:2 row_mask:0xf bank_mask:0x2
  v_mfma_f32_16x16x32_bf16 v[196:199], v[68:71], v[24:27], 0
  v_mov_b32_dpp v32, v22 row_shr:8 row_mask:0xf bank_mask:0x4
  v_mov_b32_dpp v33, v22 quad_perm:[0,1,2,3] row_mask:0xf bank_mask:0x4
  v_mfma_f32_16x16x32_bf16 v[192:195], v[80:83], v[28:31], v[192:195]
  v_mov_b32_dpp v34, v22 row_shr:10 row_mask:0xf bank_mask:0x4
  v_mov_b32_dpp v35, v22 row_shr:2 row_mask:0xf bank_mask:0x4
  v_mfma_f32_16x16x32_bf16 v[196:199], v[84:87], v[28:31], v[196:199]
  v_mov_b32_dpp v36, v22 row_shr:12 row_mask:0xf bank_mask:0x8
  v_mov_b32_dpp v37, v22 row_shr:4 row_mask:0xf bank_mask:0x8
  v_mfma_f32_16x16x32_bf16 v[192:195], v[96:99], v[32:35], v[192:195]
  v_mov_b32_dpp v38, v22 row_shr:14 row_mask:0xf bank_mask:0x8
  v_mov_b32_dpp v39, v22 row_shr:6 row_mask:0xf bank_mask:0x8
  v_mfma_f32_16x16x32_bf16 v[196:199], v[100:103], v[32:35], v[196:199]
  v_mfma_f32_16x16x32_bf16 v[192:195], v[112:115], v[36:39], v[192:195]
  v_mfma_f32_16x16x32_bf16 v[196:199], v[116:119], v[36:39], v[196:199]
  v_mfma_f32_16x16x32_bf16 v[200:203], v[72:75], v[24:27], 0
  v_mfma_f32_16x16x32_bf16 v[200:203], v[88:91], v[28:31], v[200:203]
  v_mfma_f32_16x16x32_bf16 v[200:203], v[104:107], v[32:35], v[200:203]
  v_perm_b32 v192, v192, v11, s96
  v_perm_b32 v193, v193, v11, s97
  v_mfma_f32_16x16x32_bf16 v[200:203], v[120:123], v[36:39], v[200:203]
  v_perm_b32 v194, v194, v11, s98
  v_perm_b32 v195, v195, v11, s99
  v_mfma_f32_16x16x32_bf16 v[204:207], v[76:79], v[24:27], 0
  global_store_dwordx4 v9, v[192:195], s[40:41] offset:0 sc1
  v_mfma_f32_16x16x32_bf16 v[204:207], v[92:95], v[28:31], v[204:207]
  v_perm_b32 v196, v196, v11, s96
  v_perm_b32 v197, v197, v11, s97
  v_mfma_f32_16x16x32_bf16 v[204:207], v[108:111], v[32:35], v[204:207]
  v_perm_b32 v198, v198, v11, s98
  v_perm_b32 v199, v199, v11, s99
  v_mfma_f32_16x16x32_bf16 v[204:207], v[124:127], v[36:39], v[204:207]
  global_store_dwordx4 v9, v[196:199], s[40:41] offset:512 sc1
  v_perm_b32 v200, v200, v11, s96
  v_perm_b32 v201, v201, v11, s97
  v_perm_b32 v202, v202, v11, s98
  v_perm_b32 v203, v203, v11, s99
  global_store_dwordx4 v9, v[200:203], s[40:41] offset:1024 sc1
  s_nop 1
  v_perm_b32 v204, v204, v11, s96
  v_perm_b32 v205, v205, v11, s97
  v_perm_b32 v206, v206, v11, s98
  v_perm_b32 v207, v207, v11, s99
  global_store_dwordx4 v9, v[204:207], s[40:41] offset:1536 sc1
  s_setprio 0
  s_branch FINS
END:
  s_endpgm
.section .rodata,"a"
.p2align 6
.amdhsa_kernel recurrent_scan__ssm_conv_s4__moe_arch_mod__prompt_kernel
  .amdhsa_next_free_vgpr 256
  .amdhsa_next_free_sgpr 102
  .amdhsa_accum_offset 256
  .amdhsa_group_segment_fixed_size 0
  .amdhsa_kernarg_size 136
  .amdhsa_user_sgpr_count 2
  .amdhsa_user_sgpr_kernarg_segment_ptr 1
  .amdhsa_system_sgpr_workgroup_id_x 1
.end_amdhsa_kernel
```
